```python
import torch

def _softmax(x, axis=-1):
    return torch.softmax(x, dim=axis)
def _gelu(x):
    return torch.nn.functional.gelu(x, approximate="tanh")
def _silu(x):
    return torch.nn.functional.silu(x)
def _sigmoid(x):
    return torch.sigmoid(x)
def _layernorm(x, axis=-1, eps=1e-5):
    m = x.mean(dim=axis, keepdim=True)
    v = x.var(dim=axis, keepdim=True, unbiased=False)
    return (x - m) / torch.sqrt(v + eps)
def _scatter_add(tgt, idx, src, axis=0):
    return tgt.clone().index_add_(axis, idx, src)
def _segment_sum(src, seg, n):
    out = torch.zeros((n,) + src.shape[1:], dtype=src.dtype)
    return out.index_add_(0, seg, src)
def _pad(x, pw):
    flat = tuple(v for pair in reversed(pw) for v in pair)
    return torch.nn.functional.pad(x, flat)

kernel_name = 'gated_mix__linear_attn_block__mixer_channel_mlp__prompt'

def setup_inputs():

    _w = (lambda a: (lambda t: t.to(torch.bfloat16) if t.is_floating_point() else t)(torch.as_tensor(a)))
    def _A_setup():
        B, S, D = 1, 2048, 640
        return {
            "x": _w((lambda *s: torch.randn(*s, dtype=torch.bfloat16) * 0.05)(B, S, D)),
            "wqkv": _w((lambda *s: torch.randn(*s, dtype=torch.bfloat16) * 0.8)(D, 3 * D)),
            "wo": _w((lambda *s: torch.randn(*s, dtype=torch.bfloat16) * 0.2)(D, D)),
        }
    _A_in = _A_setup()

    def _B_setup():
        B, S, D, F = 1, 2048, 640, 1728
        return {
            "x": _w((lambda *s: torch.randn(*s, dtype=torch.bfloat16) * 0.05)(B, S, D)),
            "w1": _w((lambda *s: torch.randn(*s, dtype=torch.bfloat16) * 1.6)(D, F) * (D ** -0.5)),
            "b1": _w((lambda *s: torch.randn(*s, dtype=torch.bfloat16) * 0.8)(F)),
            "w2": _w((lambda *s: torch.randn(*s, dtype=torch.bfloat16) * 0.05)(F, D) * (F ** -0.5)),
            "b2": _w((lambda *s: torch.randn(*s, dtype=torch.bfloat16) * 0.05)(D)),
        }
    _B_in = _B_setup()

    return {
        "A_x": _A_in["x"],
        "A_wqkv": _A_in["wqkv"],
        "A_wo": _A_in["wo"],
        "B_x": _B_in["x"],
        "B_w1": _B_in["w1"],
        "B_b1": _B_in["b1"],
        "B_w2": _B_in["w2"],
        "B_b2": _B_in["b2"],
        "gate_w": _w((lambda *s: torch.randn(*s, dtype=torch.bfloat16) * 0.05)(640) * 16.0),
    }

def reference(A_x, A_wqkv, A_wo, B_x, B_w1, B_b1, B_w2, B_b2, gate_w):
    def _A_ref(x, wqkv, wo):
        B, S, D = x.shape
        H = 32; Dh = D // H
        qkv = (lambda x, *d: x.permute(*d))((x @ wqkv).reshape(B, S, 3, H, Dh), 2, 0, 3, 1, 4)
        q, k, v = qkv[0], qkv[1], qkv[2]
        phi = lambda t: torch.where(t > 0, t + 1, torch.exp(t)) + 1e-6
        pq, pk = phi(q), phi(k)
        kv = torch.einsum("bhsd,bhse->bhde", pk, v)
        z = torch.einsum("bhsd->bhd", pk)
        num = torch.einsum("bhqd,bhde->bhqe", pq, kv)
        den = torch.einsum("bhqd,bhd->bhq", pq, z)[..., None] + 1e-6
        o = num / den
        return (lambda x, *d: x.permute(*d))(o, 0, 2, 1, 3).reshape(B, S, D) @ wo

    def _B_ref(x, w1, b1, w2, b2):
        y = _layernorm(x, axis=-1)
        h = _gelu(torch.einsum("bsd,df->bsf", y, w1) + b1)
        return torch.einsum("bsf,fd->bsd", h, w2) + b2

    x = A_x
    g = _sigmoid((x * gate_w).sum(-1, keepdims=True))
    a = _A_ref(x, A_wqkv, A_wo)
    b = _B_ref(x, B_w1, B_b1, B_w2, B_b2)
    return g * a + (1 - g) * b
```

```asm
; @launch grid=(256,1,1) block=(512,1,1) lds=153600
.amdgcn_target "amdgcn-amd-amdhsa--gfx950"
.text
.globl gated_mix__linear_attn_block__mixer_channel_mlp__prompt_kernel
.p2align 8
.type gated_mix__linear_attn_block__mixer_channel_mlp__prompt_kernel,@function
gated_mix__linear_attn_block__mixer_channel_mlp__prompt_kernel:
    s_cmp_ge_u32 s2, 256
    s_cbranch_scc1 L_end
    s_setprio 3
    s_load_dwordx16 s[4:19], s[0:1], 0
    s_load_dwordx8 s[20:27], s[0:1], 64
    v_lshrrev_b32 v1, 6, v0
    v_and_b32 v255, 63, v0
    v_readfirstlane_b32 s76, v1
    v_and_b32 v254, 15, v0
    v_bfe_u32 v253, v0, 4, 2
    v_lshlrev_b32 v252, 4, v255
    s_and_b32 s83, s2, 7
    s_lshr_b32 s3, s2, 3
    s_and_b32 s84, s83, 1
    s_lshr_b32 s83, s83, 1
    s_and_b32 s85, s3, 7
    s_lshr_b32 s3, s3, 3
    s_lshl_b32 s77, s84, 3
    s_add_u32 s77, s77, s85
    s_lshl_b32 s78, s3, 2
    s_add_u32 s78, s78, s83
    s_lshl_b32 s81, s83, 3
    s_add_u32 s81, s81, s85
    s_lshl_b32 s82, s84, 2
    s_add_u32 s82, s82, s3
    s_and_b32 s79, s76, 3
    s_lshr_b32 s80, s76, 2
    s_lshl_b32 s83, s2, 3
    s_add_u32 s83, s83, s76
    v_mov_b32 v11, 1073741824
    s_lshl_b32 s86, s76, 10
    s_mul_i32 s87, s78, 163840
    s_add_u32 s87, s87, s86
    v_lshrrev_b32 v1, 3, v255
    s_lshl_b32 s84, s76, 3
    v_add_u32 v1, s84, v1
    v_bfe_u32 v2, v1, 1, 3
    v_and_b32 v3, 7, v255
    v_xor_b32 v2, v2, v3
    s_lshl_b32 s84, s77, 7
    v_add_u32 v1, s84, v1
    v_mul_u32_u24 v1, 1280, v1
    v_lshl_add_u32 v244, v2, 4, v1
    s_lshl_b32 s84, s76, 2
    v_add_u32 v1, s84, v253
    s_lshl_b32 s84, s76, 1
    s_and_b32 s84, s84, 4
    v_or_b32 v2, s84, v253
    v_lshlrev_b32 v2, 1, v2
    v_xor_b32 v2, v2, v254
    s_lshl_b32 s85, s78, 8
    v_lshl_add_u32 v2, v2, 4, s85
    v_cmp_gt_u32 vcc, 3456, v2
    v_mul_u32_u24 v1, 3456, v1
    v_add_u32 v1, v1, v2
    v_cndmask_b32 v245, v11, v1, vcc
    s_waitcnt lgkmcnt(0)
    s_mov_b32 s28, s4
    s_mov_b32 s29, s5
    s_mov_b32 s30, 2621440
    s_mov_b32 s31, 0x20000
    s_mov_b32 s40, s12
    s_mov_b32 s41, s13
    s_mov_b32 s42, 2211840
    s_mov_b32 s43, 0x20000
    s_add_u32 m0, s86, 0
    s_mov_b32 s4, 0
    buffer_load_dwordx4 v244, s[28:31], s4 offen lds
    s_add_u32 m0, s86, 16384
    s_mov_b32 s4, 0
    buffer_load_dwordx4 v245, s[40:43], s4 offen lds
    s_add_u32 m0, s86, 8192
    s_mov_b32 s4, 81920
    buffer_load_dwordx4 v244, s[28:31], s4 offen lds
    s_add_u32 m0, s86, 24576
    s_mov_b32 s4, 110592
    buffer_load_dwordx4 v245, s[40:43], s4 offen lds
    s_setprio 2
    s_mov_b32 s56, s20
    s_mov_b32 s57, s21
    s_mov_b32 s58, 1280
    s_mov_b32 s59, 0x20000
    v_lshlrev_b32 v9, 2, v255
    s_lshl_b32 s4, s77, 4
    s_add_u32 s4, s4, s78
    s_lshl_b32 s4, s4, 3
    s_add_u32 s89, s4, s76
    s_mul_i32 s4, s89, 1280
    buffer_load_dwordx4 v[40:43], v252, s[28:31], s4 offen
    buffer_load_dword v48, v9, s[28:31], s4 offen offset:1024
    buffer_load_dwordx4 v[44:47], v252, s[56:59], 0 offen
    buffer_load_dword v49, v9, s[56:59], 0 offen offset:1024
    s_lshl_b32 s5, s78, 8
    v_add_u32 v10, s5, v9
    v_cmp_gt_u32 vcc, 3456, v10
    s_nop 1
    v_cndmask_b32 v10, v11, v10, vcc
    s_lshl_b32 s4, s77, 3
    s_add_u32 s4, s4, s76
    s_mul_i32 s4, s4, 17280
    buffer_load_dword v50, v10, s[40:43], s4 offen
    s_add_u32 s4, s4, 3456
    buffer_load_dword v51, v10, s[40:43], s4 offen
    s_add_u32 s4, s4, 3456
    buffer_load_dword v52, v10, s[40:43], s4 offen
    s_add_u32 s4, s4, 3456
    buffer_load_dword v53, v10, s[40:43], s4 offen
    s_add_u32 s4, s4, 3456
    buffer_load_dword v54, v10, s[40:43], s4 offen
    s_add_u32 s4, s4, 3456
    s_setprio 1
    s_mov_b32 s44, s14
    s_mov_b32 s45, s15
    s_mov_b32 s46, 3456
    s_mov_b32 s47, 0x20000
    s_mov_b32 s48, s16
    s_mov_b32 s49, s17
    s_mov_b32 s50, 2211840
    s_mov_b32 s51, 0x20000
    s_mov_b32 s52, s18
    s_mov_b32 s53, s19
    s_mov_b32 s54, 1280
    s_mov_b32 s55, 0x20000
    s_mov_b32 s60, s22
    s_mov_b32 s61, s23
    s_mov_b32 s62, 2621440
    s_mov_b32 s63, 0x20000
    s_mov_b32 s64, s24
    s_mov_b32 s65, s25
    s_mov_b32 s66, 256
    s_mov_b32 s67, 0x20000
    s_mov_b32 s68, s26
    s_mov_b32 s69, s27
    s_mov_b32 s70, 17039360
    s_mov_b32 s71, 0x20000
    s_lshl_b32 s84, s2, 2
    s_add_u32 s84, s84, s79
    s_lshl_b32 s5, s76, 8
    s_sub_u32 s85, 255, s2
    s_add_u32 s5, s5, s85
    s_cmp_eq_u32 s80, 0
    s_cselect_b32 s84, s84, s5
    v_mov_b32 v20, v252
    s_cmp_ge_u32 s84, 1072
    s_cbranch_scc1 L_rn
    v_and_b32 v22, 3, v254
    s_cmp_lt_u32 s84, 480
    s_cbranch_scc1 L_rq
    s_sub_u32 s85, s84, 480
    s_lshr_b32 s5, s85, 3
    s_and_b32 s6, s85, 7
    s_mul_i32 s15, s6, 378880
    s_mul_i32 s7, s5, 5120
    s_add_u32 s15, s15, s7
    s_add_u32 s15, s15, 2621440
    s_add_u32 s17, s15, 4096
    s_mov_b32 s16, 2048
    s_mov_b32 s14, 8
    s_mov_b32 s18, 56
    s_mov_b32 s19, 4
    s_mov_b32 s13, 1280
    s_mov_b32 s11, 4
    s_mul_i32 s6, s6, 160
    v_lshlrev_b32 v21, 3, v22
    v_add_u32 v21, 128, v21
    s_cmp_lt_u32 s5, 54
    s_cbranch_scc1 L_r2
    s_mov_b32 s72, s8
    s_mov_b32 s73, s9
    s_mov_b32 s74, 819200
    s_mov_b32 s75, 0x20000
    s_mov_b32 s12, 20
    s_mul_i32 s7, s5, 40
    s_sub_u32 s8, s7, 2160
    s_lshl_b32 s7, s7, 2
    s_sub_u32 s7, s7, 11184
    s_cmp_ge_u32 s5, 70
    s_cselect_b32 s8, s7, s8
    s_cselect_b32 s11, 40, 4
    s_mul_i32 s10, s8, 1280
    s_add_u32 s10, s10, s6
    s_branch L_rc
L_r2:
    s_mov_b32 s72, s48
    s_mov_b32 s73, s49
    s_mov_b32 s74, 2211840
    s_mov_b32 s75, 0x20000
    s_mov_b32 s12, 16
    s_mul_i32 s10, s5, 40960
    s_add_u32 s10, s10, s6
    s_branch L_rc
L_rq:
    s_mov_b32 s72, s6
    s_mov_b32 s73, s7
    s_mov_b32 s74, 2457600
    s_mov_b32 s75, 0x20000
    s_mul_hi_u32 s5, s84, 0xAAAAAAB
    s_mul_i32 s6, s5, 24
    s_sub_u32 s6, s84, s6
    s_mul_i32 s10, s5, 122880
    s_mul_i32 s7, s6, 160
    s_add_u32 s10, s10, s7
    s_and_b32 s7, s6, 7
    s_mul_i32 s7, s7, 327680
    s_lshl_b32 s5, s5, 13
    s_add_u32 s7, s7, s5
    s_lshr_b32 s6, s6, 3
    s_sub_u32 s8, s6, 1
    s_lshl_b32 s9, s8, 11
    s_lshl_b32 s8, s8, 7
    s_add_u32 s8, s8, 4096
    s_cmp_eq_u32 s6, 0
    s_cselect_b32 s9, 5120, s9
    s_cselect_b32 s8, 7168, s8
    s_add_u32 s15, s7, s9
    s_add_u32 s17, s7, s8
    s_mov_b32 s16, 163840
    s_mov_b32 s14, 40
    s_mov_b32 s18, 40
    s_mov_b32 s19, 3
    s_mov_b32 s13, 3840
    s_mov_b32 s11, 8
    s_mov_b32 s12, 4
    v_lshrrev_b32 v20, 3, v254
    v_mul_u32_u24 v20, 163712, v20
    v_add_u32 v20, v20, v252
    v_mul_u32_u24 v21, 40, v22
    v_add_u32 v21, 32, v21
L_rc:
    s_mul_i32 s85, s76, 5120
    s_add_u32 s85, s85, 98304
    v_add_u32 v1, 0, v255
    v_mul_u32_u24 v2, 6554, v1
    v_lshrrev_b32 v2, 16, v2
    v_mul_u32_u24 v3, 10, v2
    v_sub_u32 v1, v1, v3
    v_lshrrev_b32 v3, 3, v2
    v_and_b32 v4, 3, v2
    v_mad_u32_u24 v4, v3, s11, v4
    v_bfe_u32 v3, v2, 2, 1
    v_mad_u32_u24 v4, v3, s12, v4
    v_mul_u32_u24 v4, s13, v4
    s_add_u32 m0, s85, 0
    v_lshl_add_u32 v4, v1, 4, v4
    buffer_load_dwordx4 v4, s[72:75], s10 offen lds
    v_add_u32 v1, 64, v255
    v_mul_u32_u24 v2, 6554, v1
    v_lshrrev_b32 v2, 16, v2
    v_mul_u32_u24 v3, 10, v2
    v_sub_u32 v1, v1, v3
    v_lshrrev_b32 v3, 3, v2
    v_and_b32 v4, 3, v2
    v_mad_u32_u24 v4, v3, s11, v4
    v_bfe_u32 v3, v2, 2, 1
    v_mad_u32_u24 v4, v3, s12, v4
    v_mul_u32_u24 v4, s13, v4
    s_add_u32 m0, s85, 1024
    v_lshl_add_u32 v4, v1, 4, v4
    buffer_load_dwordx4 v4, s[72:75], s10 offen lds
    v_add_u32 v1, 128, v255
    v_mul_u32_u24 v2, 6554, v1
    v_lshrrev_b32 v2, 16, v2
    v_mul_u32_u24 v3, 10, v2
    v_sub_u32 v1, v1, v3
    v_lshrrev_b32 v3, 3, v2
    v_and_b32 v4, 3, v2
    v_mad_u32_u24 v4, v3, s11, v4
    v_bfe_u32 v3, v2, 2, 1
    v_mad_u32_u24 v4, v3, s12, v4
    v_mul_u32_u24 v4, s13, v4
    s_add_u32 m0, s85, 2048
    v_lshl_add_u32 v4, v1, 4, v4
    buffer_load_dwordx4 v4, s[72:75], s10 offen lds
    v_add_u32 v1, 192, v255
    v_mul_u32_u24 v2, 6554, v1
    v_lshrrev_b32 v2, 16, v2
    v_mul_u32_u24 v3, 10, v2
    v_sub_u32 v1, v1, v3
    v_lshrrev_b32 v3, 3, v2
    v_and_b32 v4, 3, v2
    v_mad_u32_u24 v4, v3, s11, v4
    v_bfe_u32 v3, v2, 2, 1
    v_mad_u32_u24 v4, v3, s12, v4
    v_mul_u32_u24 v4, s13, v4
    s_add_u32 m0, s85, 3072
    v_lshl_add_u32 v4, v1, 4, v4
    buffer_load_dwordx4 v4, s[72:75], s10 offen lds
    v_add_u32 v1, 256, v255
    v_mul_u32_u24 v2, 6554, v1
    v_lshrrev_b32 v2, 16, v2
    v_mul_u32_u24 v3, 10, v2
    v_sub_u32 v1, v1, v3
    v_lshrrev_b32 v3, 3, v2
    v_and_b32 v4, 3, v2
    v_mad_u32_u24 v4, v3, s11, v4
    v_bfe_u32 v3, v2, 2, 1
    v_mad_u32_u24 v4, v3, s12, v4
    v_mul_u32_u24 v4, s13, v4
    s_add_u32 m0, s85, 4096
    v_lshl_add_u32 v4, v1, 4, v4
    buffer_load_dwordx4 v4, s[72:75], s10 offen lds
L_rn:
    s_add_u32 m0, s86, 32768
    s_mov_b32 s4, 128
    buffer_load_dwordx4 v244, s[28:31], s4 offen lds
    s_add_u32 m0, s86, 49152
    s_mov_b32 s4, 221184
    buffer_load_dwordx4 v245, s[40:43], s4 offen lds
    s_add_u32 m0, s86, 40960
    s_mov_b32 s4, 82048
    buffer_load_dwordx4 v244, s[28:31], s4 offen lds
    s_add_u32 m0, s86, 57344
    s_mov_b32 s4, 331776
    buffer_load_dwordx4 v245, s[40:43], s4 offen lds
    s_setprio 0
    v_lshrrev_b32 v1, 1, v254
    v_xor_b32 v1, v1, v253
    s_lshl_b32 s4, s79, 12
    v_lshl_add_u32 v2, v254, 7, s4
    v_lshl_add_u32 v246, v1, 4, v2
    v_xor_b32 v247, 64, v246
    v_lshrrev_b32 v1, 2, v254
    v_lshl_add_u32 v2, v253, 3, v1
    v_lshlrev_b32 v2, 8, v2
    v_and_b32 v3, 3, v254
    v_lshl_add_u32 v2, v3, 3, v2
    v_and_b32 v3, 1, v253
    v_xor_b32 v3, s80, v3
    v_lshl_add_u32 v1, v3, 2, v1
    v_lshl_add_u32 v248, v1, 5, v2
    v_add_u32 v248, 16384, v248
    v_xor_b32 v249, 32, v248
    v_xor_b32 v250, 64, v248
    v_xor_b32 v251, 96, v248
    v_mov_b32 v4, 0
    v_mov_b32 v5, 0
    v_mov_b32 v6, 0
    v_mov_b32 v7, 0
    s_add_u32 s4, s86, 145408
    v_add_u32 v1, s4, v252
    ds_write_b128 v1, v[4:7]
    s_lshl_b32 s5, s77, 2
    s_add_u32 s5, s5, s79
    s_mul_i32 s5, s5, 151552
    s_add_u32 s88, s5, 5767168
    s_cmp_eq_u32 s80, 0
    s_cbranch_scc1 L_zA
    v_mov_b32 v4, -1
    v_mov_b32 v5, -1
    v_mov_b32 v6, -1
    v_mov_b32 v7, -1
    s_nop 0
    s_lshl_b32 s6, s78, 6
    s_add_u32 s6, s6, s79
    s_lshl_b32 s6, s6, 10
    s_add_u32 s6, s6, 15990784
    s_lshl_b32 s4, s77, 12
    s_add_u32 s6, s6, s4
    buffer_store_dwordx4 v[4:7], v252, s[68:71], s6 offen sc1
    s_nop 1
    v_mov_b32 v4, 0
L_zA:
    s_lshl_b32 s5, s2, 8
    s_add_u32 s5, s5, 15695872
    s_cmp_lt_u32 s83, 128
    s_cselect_b32 s5, s5, 1073741824
    s_cmp_eq_u32 s76, 1
    s_cselect_b32 s5, s5, 1073741824
    v_add_u32 v2, s5, v9
    buffer_store_dword v4, v2, s[68:71], 0 offen sc1
    s_waitcnt vmcnt(10)
    s_mov_b32 s4, 0x3f803f80
    v_mov_b32 v56, 0
    v_mov_b32 v57, 0
    v_mov_b32 v58, 0
    v_dot2_f32_bf16 v56, v40, s4, v56
    v_dot2_f32_bf16 v57, v40, v40, v57
    v_dot2_f32_bf16 v58, v40, v44, v58
    s_nop 0
    v_dot2_f32_bf16 v56, v41, s4, v56
    v_dot2_f32_bf16 v57, v41, v41, v57
    v_dot2_f32_bf16 v58, v41, v45, v58
    s_nop 0
    v_dot2_f32_bf16 v56, v42, s4, v56
    v_dot2_f32_bf16 v57, v42, v42, v57
    v_dot2_f32_bf16 v58, v42, v46, v58
    s_nop 0
    v_dot2_f32_bf16 v56, v43, s4, v56
    v_dot2_f32_bf16 v57, v43, v43, v57
    v_dot2_f32_bf16 v58, v43, v47, v58
    s_nop 0
    v_dot2_f32_bf16 v56, v48, s4, v56
    v_dot2_f32_bf16 v57, v48, v48, v57
    v_dot2_f32_bf16 v58, v48, v49, v58
    s_nop 0
    v_add_f32_dpp v56, v56, v56 row_ror:8 row_mask:0xf bank_mask:0xf
    v_add_f32_dpp v57, v57, v57 row_ror:8 row_mask:0xf bank_mask:0xf
    v_add_f32_dpp v58, v58, v58 row_ror:8 row_mask:0xf bank_mask:0xf
    v_add_f32_dpp v56, v56, v56 row_ror:4 row_mask:0xf bank_mask:0xf
    v_add_f32_dpp v57, v57, v57 row_ror:4 row_mask:0xf bank_mask:0xf
    v_add_f32_dpp v58, v58, v58 row_ror:4 row_mask:0xf bank_mask:0xf
    v_add_f32_dpp v56, v56, v56 row_ror:2 row_mask:0xf bank_mask:0xf
    v_add_f32_dpp v57, v57, v57 row_ror:2 row_mask:0xf bank_mask:0xf
    v_add_f32_dpp v58, v58, v58 row_ror:2 row_mask:0xf bank_mask:0xf
    v_add_f32_dpp v56, v56, v56 row_ror:1 row_mask:0xf bank_mask:0xf
    v_add_f32_dpp v57, v57, v57 row_ror:1 row_mask:0xf bank_mask:0xf
    v_add_f32_dpp v58, v58, v58 row_ror:1 row_mask:0xf bank_mask:0xf
    v_mov_b32 v60, v56
    v_mov_b32 v61, v57
    v_mov_b32 v62, v58
    v_permlane16_swap_b32 v60, v56
    v_permlane16_swap_b32 v61, v57
    v_permlane16_swap_b32 v62, v58
    v_add_f32 v56, v56, v60
    v_add_f32 v57, v57, v61
    v_add_f32 v58, v58, v62
    v_mov_b32 v60, v56
    v_mov_b32 v61, v57
    v_mov_b32 v62, v58
    v_permlane32_swap_b32 v60, v56
    v_permlane32_swap_b32 v61, v57
    v_permlane32_swap_b32 v62, v58
    v_add_f32 v56, v56, v60
    v_add_f32 v57, v57, v61
    v_add_f32 v58, v58, v62
    v_mul_f32 v56, 0x3acccccd, v56
    v_mul_f32 v57, 0x3acccccd, v57
    v_mul_f32 v58, 0xbfb8aa3b, v58
    v_fma_f32 v57, -v56, v56, v57
    v_exp_f32 v58, v58
    v_max_f32 v57, 0, v57
    v_add_f32 v57, 0x3727c5ac, v57
    v_add_f32 v58, 1.0, v58
    v_rsq_f32 v60, v57
    v_rcp_f32 v62, v58
    v_cmp_eq_u32 vcc, 0, v255
    v_mul_f32 v61, -v56, v60
    v_sub_f32 v63, 1.0, v62
    v_max_f32 v63, 0xda24260, v63
    v_rcp_f32 v63, v63
    v_cndmask_b32 v1, v11, v255, vcc
    s_lshl_b32 s4, s89, 4
    s_add_u32 s4, s4, 15466496
    buffer_store_dwordx4 v[60:63], v1, s[68:71], s4 offen sc1
    s_waitcnt vmcnt(6)
    v_lshlrev_b32 v64, 16, v50
    v_and_b32 v65, 0xffff0000, v50
    v_lshlrev_b32 v66, 16, v51
    v_and_b32 v67, 0xffff0000, v51
    v_add_f32 v64, v64, v66
    v_add_f32 v65, v65, v67
    v_lshlrev_b32 v66, 16, v52
    v_and_b32 v67, 0xffff0000, v52
    v_add_f32 v64, v64, v66
    v_add_f32 v65, v65, v67
    v_lshlrev_b32 v66, 16, v53
    v_and_b32 v67, 0xffff0000, v53
    v_add_f32 v64, v64, v66
    v_add_f32 v65, v65, v67
    v_lshlrev_b32 v66, 16, v54
    v_and_b32 v67, 0xffff0000, v54
    v_add_f32 v64, v64, v66
    v_add_f32 v65, v65, v67
    s_lshl_b32 s4, s76, 9
    s_add_u32 s4, s4, 132096
    v_lshl_add_u32 v8, v255, 3, s4
    ds_write_b64 v8, v[64:65]
    s_cmp_ge_u32 s84, 1072
    s_cbranch_scc1 L_rn2
    v_lshrrev_b32 v1, 2, v254
    v_lshl_add_u32 v1, v253, 3, v1
    v_mul_u32_u24 v1, 160, v1
    v_add_u32 v1, s85, v1
    v_add_u32 v21, v21, v1
    v_lshl_add_u32 v1, v22, s19, v1
    s_waitcnt vmcnt(6)
    ds_read_b64_tr_b16 v[96:97], v1
    ds_read_b64_tr_b16 v[98:99], v1 offset:640
    v_add_u32 v1, s14, v1
    ds_read_b64_tr_b16 v[100:101], v1
    ds_read_b64_tr_b16 v[102:103], v1 offset:640
    v_add_u32 v1, s18, v1
    ds_read_b64_tr_b16 v[104:105], v1
    ds_read_b64_tr_b16 v[106:107], v1 offset:640
    v_add_u32 v1, s14, v1
    ds_read_b64_tr_b16 v[108:109], v1
    ds_read_b64_tr_b16 v[110:111], v1 offset:640
    ds_read_b64_tr_b16 v[112:113], v21
    ds_read_b64_tr_b16 v[114:115], v21 offset:640
    s_add_u32 s16, s16, s15
    s_waitcnt lgkmcnt(8)
    buffer_store_dwordx4 v[96:99], v252, s[68:71], s15 offen offset:0 sc1
    s_waitcnt lgkmcnt(6)
    buffer_store_dwordx4 v[100:103], v252, s[68:71], s15 offen offset:1024 sc1
    s_waitcnt lgkmcnt(4)
    buffer_store_dwordx4 v[104:107], v252, s[68:71], s16 offen offset:0 sc1
    s_waitcnt lgkmcnt(2)
    buffer_store_dwordx4 v[108:111], v252, s[68:71], s16 offen offset:1024 sc1
    s_waitcnt lgkmcnt(0)
    buffer_store_dwordx4 v[112:115], v20, s[68:71], s17 offen offset:0 sc1
L_rn2:
    s_waitcnt vmcnt(15)
    s_waitcnt lgkmcnt(0)
    s_barrier
    s_cmp_lg_u32 s76, 7
    s_cbranch_scc1 L_c1done
    v_subrev_u32 v1, 3584, v8
    ds_read_b64 v[80:81], v1 offset:0
    ds_read_b64 v[82:83], v1 offset:512
    ds_read_b64 v[84:85], v1 offset:1024
    ds_read_b64 v[86:87], v1 offset:1536
    ds_read_b64 v[88:89], v1 offset:2048
    ds_read_b64 v[90:91], v1 offset:2560
    ds_read_b64 v[92:93], v1 offset:3072
    ds_read_b64 v[94:95], v1 offset:3584
    s_lshl_b32 s4, s77, 13
    s_lshl_b32 s5, s78, 9
    s_add_u32 s4, s4, s5
    s_add_u32 s4, s4, 15499264
    v_lshlrev_b32 v2, 3, v255
    s_waitcnt lgkmcnt(0)
    v_pk_add_f32 v[80:81], v[80:81], v[82:83]
    v_pk_add_f32 v[80:81], v[80:81], v[84:85]
    v_pk_add_f32 v[80:81], v[80:81], v[86:87]
    v_pk_add_f32 v[80:81], v[80:81], v[88:89]
    v_pk_add_f32 v[80:81], v[80:81], v[90:91]
    v_pk_add_f32 v[80:81], v[80:81], v[92:93]
    v_pk_add_f32 v[80:81], v[80:81], v[94:95]
    buffer_store_dwordx2 v[80:81], v2, s[68:71], s4 offen sc1
L_c1done:
    s_add_u32 m0, s86, 65536
    s_mov_b32 s4, 256
    buffer_load_dwordx4 v244, s[28:31], s4 offen lds
    s_add_u32 m0, s86, 81920
    s_mov_b32 s4, 442368
    buffer_load_dwordx4 v245, s[40:43], s4 offen lds
    s_add_u32 m0, s86, 73728
    s_mov_b32 s4, 82176
    buffer_load_dwordx4 v244, s[28:31], s4 offen lds
    s_add_u32 m0, s86, 90112
    s_mov_b32 s4, 552960
    buffer_load_dwordx4 v245, s[40:43], s4 offen lds
    ds_read_b128 v[0:3], v246 offset:0
    ds_read_b128 v[4:7], v246 offset:2048
    ds_read_b64_tr_b16 v[192:193], v248 offset:0
    ds_read_b64_tr_b16 v[194:195], v248 offset:1024
    ds_read_b64_tr_b16 v[196:197], v249 offset:0
    ds_read_b64_tr_b16 v[198:199], v249 offset:1024
    ds_read_b64_tr_b16 v[200:201], v250 offset:0
    ds_read_b64_tr_b16 v[202:203], v250 offset:1024
    ds_read_b64_tr_b16 v[204:205], v251 offset:0
    ds_read_b64_tr_b16 v[206:207], v251 offset:1024
    s_waitcnt lgkmcnt(6)
    v_mfma_f32_16x16x32_bf16 v[160:163], v[192:195], v[0:3], 0
    ds_read_b128 v[8:11], v247 offset:0
    ds_read_b128 v[12:15], v247 offset:2048
    v_mfma_f32_16x16x32_bf16 v[164:167], v[192:195], v[4:7], 0
    ds_read_b64_tr_b16 v[208:209], v248 offset:8192
    ds_read_b64_tr_b16 v[210:211], v248 offset:9216
    s_waitcnt lgkmcnt(8)
    v_mfma_f32_16x16x32_bf16 v[168:171], v[196:199], v[0:3], 0
    ds_read_b64_tr_b16 v[212:213], v249 offset:8192
    ds_read_b64_tr_b16 v[214:215], v249 offset:9216
    v_mfma_f32_16x16x32_bf16 v[172:175], v[196:199], v[4:7], 0
    ds_read_b64_tr_b16 v[216:217], v250 offset:8192
    ds_read_b64_tr_b16 v[218:219], v250 offset:9216
    s_waitcnt lgkmcnt(10)
    v_mfma_f32_16x16x32_bf16 v[176:179], v[200:203], v[0:3], 0
    ds_read_b64_tr_b16 v[220:221], v251 offset:8192
    ds_read_b64_tr_b16 v[222:223], v251 offset:9216
    v_mfma_f32_16x16x32_bf16 v[180:183], v[200:203], v[4:7], 0
    s_waitcnt lgkmcnt(10)
    v_mfma_f32_16x16x32_bf16 v[184:187], v[204:207], v[0:3], 0
    v_mfma_f32_16x16x32_bf16 v[188:191], v[204:207], v[4:7], 0
    s_waitcnt vmcnt(4)
    s_barrier
    s_cmp_lg_u32 s76, 0
    s_cbranch_scc1 L_ns1
    s_and_b32 s4, s2, 1
    s_lshl_b32 s4, s4, 7
    v_mov_b32 v240, 1
    v_mov_b32 v241, 0
    s_mov_b64 exec, 1
    buffer_atomic_add v240, v241, s[64:67], s4 offen sc1
    s_mov_b64 exec, -1
L_ns1:
    s_waitcnt lgkmcnt(6)
    v_mfma_f32_16x16x32_bf16 v[160:163], v[208:211], v[8:11], v[160:163]
    ds_read_b128 v[16:19], v246 offset:32768
    ds_read_b128 v[20:23], v246 offset:34816
    v_mfma_f32_16x16x32_bf16 v[164:167], v[208:211], v[12:15], v[164:167]
    ds_read_b64_tr_b16 v[192:193], v248 offset:32768
    ds_read_b64_tr_b16 v[194:195], v248 offset:33792
    s_waitcnt lgkmcnt(8)
    v_mfma_f32_16x16x32_bf16 v[168:171], v[212:215], v[8:11], v[168:171]
    ds_read_b64_tr_b16 v[196:197], v249 offset:32768
    ds_read_b64_tr_b16 v[198:199], v249 offset:33792
    v_mfma_f32_16x16x32_bf16 v[172:175], v[212:215], v[12:15], v[172:175]
    ds_read_b64_tr_b16 v[200:201], v250 offset:32768
    ds_read_b64_tr_b16 v[202:203], v250 offset:33792
    s_add_u32 m0, s86, 98304
    s_mov_b32 s4, 384
    buffer_load_dwordx4 v244, s[28:31], s4 offen lds
    s_waitcnt lgkmcnt(10)
    v_mfma_f32_16x16x32_bf16 v[176:179], v[216:219], v[8:11], v[176:179]
    ds_read_b64_tr_b16 v[204:205], v251 offset:32768
    ds_read_b64_tr_b16 v[206:207], v251 offset:33792
    v_mfma_f32_16x16x32_bf16 v[180:183], v[216:219], v[12:15], v[180:183]
    s_waitcnt lgkmcnt(10)
    v_mfma_f32_16x16x32_bf16 v[184:187], v[220:223], v[8:11], v[184:187]
    v_mfma_f32_16x16x32_bf16 v[188:191], v[220:223], v[12:15], v[188:191]
    s_add_u32 m0, s86, 114688
    s_mov_b32 s4, 663552
    buffer_load_dwordx4 v245, s[40:43], s4 offen lds
    s_waitcnt lgkmcnt(6)
    v_mfma_f32_16x16x32_bf16 v[160:163], v[192:195], v[16:19], v[160:163]
    ds_read_b128 v[24:27], v247 offset:32768
    ds_read_b128 v[28:31], v247 offset:34816
    v_mfma_f32_16x16x32_bf16 v[164:167], v[192:195], v[20:23], v[164:167]
    ds_read_b64_tr_b16 v[208:209], v248 offset:40960
    ds_read_b64_tr_b16 v[210:211], v248 offset:41984
    s_waitcnt lgkmcnt(8)
    v_mfma_f32_16x16x32_bf16 v[168:171], v[196:199], v[16:19], v[168:171]
    ds_read_b64_tr_b16 v[212:213], v249 offset:40960
    ds_read_b64_tr_b16 v[214:215], v249 offset:41984
    v_mfma_f32_16x16x32_bf16 v[172:175], v[196:199], v[20:23], v[172:175]
    ds_read_b64_tr_b16 v[216:217], v250 offset:40960
    ds_read_b64_tr_b16 v[218:219], v250 offset:41984
    s_add_u32 m0, s86, 106496
    s_mov_b32 s4, 82304
    buffer_load_dwordx4 v244, s[28:31], s4 offen lds
    s_waitcnt lgkmcnt(10)
    v_mfma_f32_16x16x32_bf16 v[176:179], v[200:203], v[16:19], v[176:179]
    ds_read_b64_tr_b16 v[220:221], v251 offset:40960
    ds_read_b64_tr_b16 v[222:223], v251 offset:41984
    v_mfma_f32_16x16x32_bf16 v[180:183], v[200:203], v[20:23], v[180:183]
    s_waitcnt lgkmcnt(10)
    v_mfma_f32_16x16x32_bf16 v[184:187], v[204:207], v[16:19], v[184:187]
    v_mfma_f32_16x16x32_bf16 v[188:191], v[204:207], v[20:23], v[188:191]
    s_add_u32 m0, s86, 122880
    s_mov_b32 s4, 774144
    buffer_load_dwordx4 v245, s[40:43], s4 offen lds
    s_waitcnt vmcnt(4)
    s_barrier
    s_waitcnt lgkmcnt(6)
    v_mfma_f32_16x16x32_bf16 v[160:163], v[208:211], v[24:27], v[160:163]
    v_xor_b32 v246, 0x10000, v246
    v_xor_b32 v247, 0x10000, v247
    v_xor_b32 v248, 0x10000, v248
    v_xor_b32 v249, 0x10000, v249
    v_xor_b32 v250, 0x10000, v250
    v_xor_b32 v251, 0x10000, v251
    ds_read_b128 v[32:35], v246 offset:0
    v_mfma_f32_16x16x32_bf16 v[164:167], v[208:211], v[28:31], v[164:167]
    ds_read_b128 v[36:39], v246 offset:2048
    ds_read_b64_tr_b16 v[192:193], v248 offset:0
    s_waitcnt lgkmcnt(7)
    v_mfma_f32_16x16x32_bf16 v[168:171], v[212:215], v[24:27], v[168:171]
    ds_read_b64_tr_b16 v[194:195], v248 offset:1024
    ds_read_b64_tr_b16 v[196:197], v249 offset:0
    v_mfma_f32_16x16x32_bf16 v[172:175], v[212:215], v[28:31], v[172:175]
    ds_read_b64_tr_b16 v[198:199], v249 offset:1024
    ds_read_b64_tr_b16 v[200:201], v250 offset:0
    s_add_u32 m0, s86, 0
    s_mov_b32 s4, 512
    buffer_load_dwordx4 v244, s[28:31], s4 offen lds
    s_waitcnt lgkmcnt(9)
    v_mfma_f32_16x16x32_bf16 v[176:179], v[216:219], v[24:27], v[176:179]
    ds_read_b64_tr_b16 v[202:203], v250 offset:1024
    ds_read_b64_tr_b16 v[204:205], v251 offset:0
    v_mfma_f32_16x16x32_bf16 v[180:183], v[216:219], v[28:31], v[180:183]
    ds_read_b64_tr_b16 v[206:207], v251 offset:1024
    s_waitcnt lgkmcnt(10)
    v_mfma_f32_16x16x32_bf16 v[184:187], v[220:223], v[24:27], v[184:187]
    v_mfma_f32_16x16x32_bf16 v[188:191], v[220:223], v[28:31], v[188:191]
    s_add_u32 m0, s86, 16384
    s_mov_b32 s4, 884736
    buffer_load_dwordx4 v245, s[40:43], s4 offen lds
    s_waitcnt lgkmcnt(6)
    v_mfma_f32_16x16x32_bf16 v[160:163], v[192:195], v[32:35], v[160:163]
    ds_read_b128 v[40:43], v247 offset:0
    ds_read_b128 v[44:47], v247 offset:2048
    v_mfma_f32_16x16x32_bf16 v[164:167], v[192:195], v[36:39], v[164:167]
    ds_read_b64_tr_b16 v[208:209], v248 offset:8192
    ds_read_b64_tr_b16 v[210:211], v248 offset:9216
    s_waitcnt lgkmcnt(8)
    v_mfma_f32_16x16x32_bf16 v[168:171], v[196:199], v[32:35], v[168:171]
    ds_read_b64_tr_b16 v[212:213], v249 offset:8192
    ds_read_b64_tr_b16 v[214:215], v249 offset:9216
    v_mfma_f32_16x16x32_bf16 v[172:175], v[196:199], v[36:39], v[172:175]
    ds_read_b64_tr_b16 v[216:217], v250 offset:8192
    ds_read_b64_tr_b16 v[218:219], v250 offset:9216
    s_add_u32 m0, s86, 8192
    s_mov_b32 s4, 82432
    buffer_load_dwordx4 v244, s[28:31], s4 offen lds
    s_waitcnt lgkmcnt(10)
    v_mfma_f32_16x16x32_bf16 v[176:179], v[200:203], v[32:35], v[176:179]
    ds_read_b64_tr_b16 v[220:221], v251 offset:8192
    ds_read_b64_tr_b16 v[222:223], v251 offset:9216
    v_mfma_f32_16x16x32_bf16 v[180:183], v[200:203], v[36:39], v[180:183]
    s_waitcnt lgkmcnt(10)
    v_mfma_f32_16x16x32_bf16 v[184:187], v[204:207], v[32:35], v[184:187]
    v_mfma_f32_16x16x32_bf16 v[188:191], v[204:207], v[36:39], v[188:191]
    s_add_u32 m0, s86, 24576
    s_mov_b32 s4, 995328
    buffer_load_dwordx4 v245, s[40:43], s4 offen lds
    s_waitcnt vmcnt(4)
    s_barrier
    s_waitcnt lgkmcnt(6)
    v_mfma_f32_16x16x32_bf16 v[160:163], v[208:211], v[40:43], v[160:163]
    ds_read_b128 v[48:51], v246 offset:32768
    ds_read_b128 v[52:55], v246 offset:34816
    v_mfma_f32_16x16x32_bf16 v[164:167], v[208:211], v[44:47], v[164:167]
    ds_read_b64_tr_b16 v[192:193], v248 offset:32768
    ds_read_b64_tr_b16 v[194:195], v248 offset:33792
    s_waitcnt lgkmcnt(8)
    v_mfma_f32_16x16x32_bf16 v[168:171], v[212:215], v[40:43], v[168:171]
    ds_read_b64_tr_b16 v[196:197], v249 offset:32768
    ds_read_b64_tr_b16 v[198:199], v249 offset:33792
    v_mfma_f32_16x16x32_bf16 v[172:175], v[212:215], v[44:47], v[172:175]
    ds_read_b64_tr_b16 v[200:201], v250 offset:32768
    ds_read_b64_tr_b16 v[202:203], v250 offset:33792
    s_add_u32 m0, s86, 32768
    s_mov_b32 s4, 640
    buffer_load_dwordx4 v244, s[28:31], s4 offen lds
    s_waitcnt lgkmcnt(10)
    v_mfma_f32_16x16x32_bf16 v[176:179], v[216:219], v[40:43], v[176:179]
    ds_read_b64_tr_b16 v[204:205], v251 offset:32768
    ds_read_b64_tr_b16 v[206:207], v251 offset:33792
    v_mfma_f32_16x16x32_bf16 v[180:183], v[216:219], v[44:47], v[180:183]
    s_waitcnt lgkmcnt(10)
    v_mfma_f32_16x16x32_bf16 v[184:187], v[220:223], v[40:43], v[184:187]
    v_mfma_f32_16x16x32_bf16 v[188:191], v[220:223], v[44:47], v[188:191]
    s_add_u32 m0, s86, 49152
    s_mov_b32 s4, 1105920
    buffer_load_dwordx4 v245, s[40:43], s4 offen lds
    s_waitcnt lgkmcnt(6)
    v_mfma_f32_16x16x32_bf16 v[160:163], v[192:195], v[48:51], v[160:163]
    ds_read_b128 v[56:59], v247 offset:32768
    ds_read_b128 v[60:63], v247 offset:34816
    v_mfma_f32_16x16x32_bf16 v[164:167], v[192:195], v[52:55], v[164:167]
    ds_read_b64_tr_b16 v[208:209], v248 offset:40960
    ds_read_b64_tr_b16 v[210:211], v248 offset:41984
    s_waitcnt lgkmcnt(8)
    v_mfma_f32_16x16x32_bf16 v[168:171], v[196:199], v[48:51], v[168:171]
    ds_read_b64_tr_b16 v[212:213], v249 offset:40960
    ds_read_b64_tr_b16 v[214:215], v249 offset:41984
    v_mfma_f32_16x16x32_bf16 v[172:175], v[196:199], v[52:55], v[172:175]
    ds_read_b64_tr_b16 v[216:217], v250 offset:40960
    ds_read_b64_tr_b16 v[218:219], v250 offset:41984
    s_add_u32 m0, s86, 40960
    s_mov_b32 s4, 82560
    buffer_load_dwordx4 v244, s[28:31], s4 offen lds
    s_waitcnt lgkmcnt(10)
    v_mfma_f32_16x16x32_bf16 v[176:179], v[200:203], v[48:51], v[176:179]
    ds_read_b64_tr_b16 v[220:221], v251 offset:40960
    ds_read_b64_tr_b16 v[222:223], v251 offset:41984
    v_mfma_f32_16x16x32_bf16 v[180:183], v[200:203], v[52:55], v[180:183]
    s_waitcnt lgkmcnt(10)
    v_mfma_f32_16x16x32_bf16 v[184:187], v[204:207], v[48:51], v[184:187]
    v_mfma_f32_16x16x32_bf16 v[188:191], v[204:207], v[52:55], v[188:191]
    s_add_u32 m0, s86, 57344
    s_mov_b32 s4, 1216512
    buffer_load_dwordx4 v245, s[40:43], s4 offen lds
    s_waitcnt vmcnt(4)
    s_barrier
    s_waitcnt lgkmcnt(6)
    v_mfma_f32_16x16x32_bf16 v[160:163], v[208:211], v[56:59], v[160:163]
    v_xor_b32 v246, 0x10000, v246
    v_xor_b32 v247, 0x10000, v247
    v_xor_b32 v248, 0x10000, v248
    v_xor_b32 v249, 0x10000, v249
    v_xor_b32 v250, 0x10000, v250
    v_xor_b32 v251, 0x10000, v251
    ds_read_b128 v[64:67], v246 offset:0
    v_mfma_f32_16x16x32_bf16 v[164:167], v[208:211], v[60:63], v[164:167]
    ds_read_b128 v[68:71], v246 offset:2048
    ds_read_b64_tr_b16 v[192:193], v248 offset:0
    s_waitcnt lgkmcnt(7)
    v_mfma_f32_16x16x32_bf16 v[168:171], v[212:215], v[56:59], v[168:171]
    ds_read_b64_tr_b16 v[194:195], v248 offset:1024
    ds_read_b64_tr_b16 v[196:197], v249 offset:0
    v_mfma_f32_16x16x32_bf16 v[172:175], v[212:215], v[60:63], v[172:175]
    ds_read_b64_tr_b16 v[198:199], v249 offset:1024
    ds_read_b64_tr_b16 v[200:201], v250 offset:0
    s_add_u32 m0, s86, 65536
    s_mov_b32 s4, 768
    buffer_load_dwordx4 v244, s[28:31], s4 offen lds
    s_waitcnt lgkmcnt(9)
    v_mfma_f32_16x16x32_bf16 v[176:179], v[216:219], v[56:59], v[176:179]
    ds_read_b64_tr_b16 v[202:203], v250 offset:1024
    ds_read_b64_tr_b16 v[204:205], v251 offset:0
    v_mfma_f32_16x16x32_bf16 v[180:183], v[216:219], v[60:63], v[180:183]
    ds_read_b64_tr_b16 v[206:207], v251 offset:1024
    s_waitcnt lgkmcnt(10)
    v_mfma_f32_16x16x32_bf16 v[184:187], v[220:223], v[56:59], v[184:187]
    v_mfma_f32_16x16x32_bf16 v[188:191], v[220:223], v[60:63], v[188:191]
    s_add_u32 m0, s86, 81920
    s_mov_b32 s4, 1327104
    buffer_load_dwordx4 v245, s[40:43], s4 offen lds
    s_waitcnt lgkmcnt(6)
    v_mfma_f32_16x16x32_bf16 v[160:163], v[192:195], v[64:67], v[160:163]
    ds_read_b128 v[72:75], v247 offset:0
    ds_read_b128 v[76:79], v247 offset:2048
    v_mfma_f32_16x16x32_bf16 v[164:167], v[192:195], v[68:71], v[164:167]
    ds_read_b64_tr_b16 v[208:209], v248 offset:8192
    ds_read_b64_tr_b16 v[210:211], v248 offset:9216
    s_waitcnt lgkmcnt(8)
    v_mfma_f32_16x16x32_bf16 v[168:171], v[196:199], v[64:67], v[168:171]
    ds_read_b64_tr_b16 v[212:213], v249 offset:8192
    ds_read_b64_tr_b16 v[214:215], v249 offset:9216
    v_mfma_f32_16x16x32_bf16 v[172:175], v[196:199], v[68:71], v[172:175]
    ds_read_b64_tr_b16 v[216:217], v250 offset:8192
    ds_read_b64_tr_b16 v[218:219], v250 offset:9216
    s_add_u32 m0, s86, 73728
    s_mov_b32 s4, 82688
    buffer_load_dwordx4 v244, s[28:31], s4 offen lds
    s_waitcnt lgkmcnt(10)
    v_mfma_f32_16x16x32_bf16 v[176:179], v[200:203], v[64:67], v[176:179]
    ds_read_b64_tr_b16 v[220:221], v251 offset:8192
    ds_read_b64_tr_b16 v[222:223], v251 offset:9216
    v_mfma_f32_16x16x32_bf16 v[180:183], v[200:203], v[68:71], v[180:183]
    s_waitcnt lgkmcnt(10)
    v_mfma_f32_16x16x32_bf16 v[184:187], v[204:207], v[64:67], v[184:187]
    v_mfma_f32_16x16x32_bf16 v[188:191], v[204:207], v[68:71], v[188:191]
    s_add_u32 m0, s86, 90112
    s_mov_b32 s4, 1437696
    buffer_load_dwordx4 v245, s[40:43], s4 offen lds
    s_waitcnt vmcnt(4)
    s_barrier
    s_waitcnt lgkmcnt(6)
    v_mfma_f32_16x16x32_bf16 v[160:163], v[208:211], v[72:75], v[160:163]
    ds_read_b128 v[80:83], v246 offset:32768
    ds_read_b128 v[84:87], v246 offset:34816
    v_mfma_f32_16x16x32_bf16 v[164:167], v[208:211], v[76:79], v[164:167]
    ds_read_b64_tr_b16 v[192:193], v248 offset:32768
    ds_read_b64_tr_b16 v[194:195], v248 offset:33792
    s_waitcnt lgkmcnt(8)
    v_mfma_f32_16x16x32_bf16 v[168:171], v[212:215], v[72:75], v[168:171]
    ds_read_b64_tr_b16 v[196:197], v249 offset:32768
    ds_read_b64_tr_b16 v[198:199], v249 offset:33792
    v_mfma_f32_16x16x32_bf16 v[172:175], v[212:215], v[76:79], v[172:175]
    ds_read_b64_tr_b16 v[200:201], v250 offset:32768
    ds_read_b64_tr_b16 v[202:203], v250 offset:33792
    s_add_u32 m0, s86, 98304
    s_mov_b32 s4, 896
    buffer_load_dwordx4 v244, s[28:31], s4 offen lds
    s_waitcnt lgkmcnt(10)
    v_mfma_f32_16x16x32_bf16 v[176:179], v[216:219], v[72:75], v[176:179]
    ds_read_b64_tr_b16 v[204:205], v251 offset:32768
    ds_read_b64_tr_b16 v[206:207], v251 offset:33792
    v_mfma_f32_16x16x32_bf16 v[180:183], v[216:219], v[76:79], v[180:183]
    s_waitcnt lgkmcnt(10)
    v_mfma_f32_16x16x32_bf16 v[184:187], v[220:223], v[72:75], v[184:187]
    v_mfma_f32_16x16x32_bf16 v[188:191], v[220:223], v[76:79], v[188:191]
    s_add_u32 m0, s86, 114688
    s_mov_b32 s4, 1548288
    buffer_load_dwordx4 v245, s[40:43], s4 offen lds
    s_waitcnt lgkmcnt(6)
    v_mfma_f32_16x16x32_bf16 v[160:163], v[192:195], v[80:83], v[160:163]
    ds_read_b128 v[88:91], v247 offset:32768
    ds_read_b128 v[92:95], v247 offset:34816
    v_mfma_f32_16x16x32_bf16 v[164:167], v[192:195], v[84:87], v[164:167]
    ds_read_b64_tr_b16 v[208:209], v248 offset:40960
    ds_read_b64_tr_b16 v[210:211], v248 offset:41984
    s_waitcnt lgkmcnt(8)
    v_mfma_f32_16x16x32_bf16 v[168:171], v[196:199], v[80:83], v[168:171]
    ds_read_b64_tr_b16 v[212:213], v249 offset:40960
    ds_read_b64_tr_b16 v[214:215], v249 offset:41984
    v_mfma_f32_16x16x32_bf16 v[172:175], v[196:199], v[84:87], v[172:175]
    ds_read_b64_tr_b16 v[216:217], v250 offset:40960
    ds_read_b64_tr_b16 v[218:219], v250 offset:41984
    s_add_u32 m0, s86, 106496
    s_mov_b32 s4, 82816
    buffer_load_dwordx4 v244, s[28:31], s4 offen lds
    s_waitcnt lgkmcnt(10)
    v_mfma_f32_16x16x32_bf16 v[176:179], v[200:203], v[80:83], v[176:179]
    ds_read_b64_tr_b16 v[220:221], v251 offset:40960
    ds_read_b64_tr_b16 v[222:223], v251 offset:41984
    v_mfma_f32_16x16x32_bf16 v[180:183], v[200:203], v[84:87], v[180:183]
    s_waitcnt lgkmcnt(10)
    v_mfma_f32_16x16x32_bf16 v[184:187], v[204:207], v[80:83], v[184:187]
    v_mfma_f32_16x16x32_bf16 v[188:191], v[204:207], v[84:87], v[188:191]
    s_add_u32 m0, s86, 122880
    s_mov_b32 s4, 1658880
    buffer_load_dwordx4 v245, s[40:43], s4 offen lds
    s_waitcnt vmcnt(4)
    s_barrier
    s_waitcnt lgkmcnt(6)
    v_mfma_f32_16x16x32_bf16 v[160:163], v[208:211], v[88:91], v[160:163]
    v_xor_b32 v246, 0x10000, v246
    v_xor_b32 v247, 0x10000, v247
    v_xor_b32 v248, 0x10000, v248
    v_xor_b32 v249, 0x10000, v249
    v_xor_b32 v250, 0x10000, v250
    v_xor_b32 v251, 0x10000, v251
    ds_read_b128 v[96:99], v246 offset:0
    v_mfma_f32_16x16x32_bf16 v[164:167], v[208:211], v[92:95], v[164:167]
    ds_read_b128 v[100:103], v246 offset:2048
    ds_read_b64_tr_b16 v[192:193], v248 offset:0
    s_waitcnt lgkmcnt(7)
    v_mfma_f32_16x16x32_bf16 v[168:171], v[212:215], v[88:91], v[168:171]
    ds_read_b64_tr_b16 v[194:195], v248 offset:1024
    ds_read_b64_tr_b16 v[196:197], v249 offset:0
    v_mfma_f32_16x16x32_bf16 v[172:175], v[212:215], v[92:95], v[172:175]
    ds_read_b64_tr_b16 v[198:199], v249 offset:1024
    ds_read_b64_tr_b16 v[200:201], v250 offset:0
    s_add_u32 m0, s86, 0
    s_mov_b32 s4, 1024
    buffer_load_dwordx4 v244, s[28:31], s4 offen lds
    s_waitcnt lgkmcnt(9)
    v_mfma_f32_16x16x32_bf16 v[176:179], v[216:219], v[88:91], v[176:179]
    ds_read_b64_tr_b16 v[202:203], v250 offset:1024
    ds_read_b64_tr_b16 v[204:205], v251 offset:0
    v_mfma_f32_16x16x32_bf16 v[180:183], v[216:219], v[92:95], v[180:183]
    ds_read_b64_tr_b16 v[206:207], v251 offset:1024
    s_waitcnt lgkmcnt(10)
    v_mfma_f32_16x16x32_bf16 v[184:187], v[220:223], v[88:91], v[184:187]
    v_mfma_f32_16x16x32_bf16 v[188:191], v[220:223], v[92:95], v[188:191]
    s_add_u32 m0, s86, 16384
    s_mov_b32 s4, 1769472
    buffer_load_dwordx4 v245, s[40:43], s4 offen lds
    s_waitcnt lgkmcnt(6)
    v_mfma_f32_16x16x32_bf16 v[160:163], v[192:195], v[96:99], v[160:163]
    ds_read_b128 v[104:107], v247 offset:0
    ds_read_b128 v[108:111], v247 offset:2048
    v_mfma_f32_16x16x32_bf16 v[164:167], v[192:195], v[100:103], v[164:167]
    ds_read_b64_tr_b16 v[208:209], v248 offset:8192
    ds_read_b64_tr_b16 v[210:211], v248 offset:9216
    s_waitcnt lgkmcnt(8)
    v_mfma_f32_16x16x32_bf16 v[168:171], v[196:199], v[96:99], v[168:171]
    ds_read_b64_tr_b16 v[212:213], v249 offset:8192
    ds_read_b64_tr_b16 v[214:215], v249 offset:9216
    v_mfma_f32_16x16x32_bf16 v[172:175], v[196:199], v[100:103], v[172:175]
    ds_read_b64_tr_b16 v[216:217], v250 offset:8192
    ds_read_b64_tr_b16 v[218:219], v250 offset:9216
    s_add_u32 m0, s86, 8192
    s_mov_b32 s4, 82944
    buffer_load_dwordx4 v244, s[28:31], s4 offen lds
    s_waitcnt lgkmcnt(10)
    v_mfma_f32_16x16x32_bf16 v[176:179], v[200:203], v[96:99], v[176:179]
    ds_read_b64_tr_b16 v[220:221], v251 offset:8192
    ds_read_b64_tr_b16 v[222:223], v251 offset:9216
    v_mfma_f32_16x16x32_bf16 v[180:183], v[200:203], v[100:103], v[180:183]
    s_waitcnt lgkmcnt(10)
    v_mfma_f32_16x16x32_bf16 v[184:187], v[204:207], v[96:99], v[184:187]
    v_mfma_f32_16x16x32_bf16 v[188:191], v[204:207], v[100:103], v[188:191]
    s_add_u32 m0, s86, 24576
    s_mov_b32 s4, 1880064
    buffer_load_dwordx4 v245, s[40:43], s4 offen lds
    s_waitcnt vmcnt(4)
    s_barrier
    v_and_b32 v241, 1, v255
    v_lshlrev_b32 v241, 7, v241
    s_cmp_lg_u32 s76, 0
    s_cbranch_scc1 L_np6
    buffer_load_dword v240, v241, s[64:67], 0 offen sc1
L_np6:
    s_waitcnt lgkmcnt(6)
    v_mfma_f32_16x16x32_bf16 v[160:163], v[208:211], v[104:107], v[160:163]
    ds_read_b128 v[112:115], v246 offset:32768
    ds_read_b128 v[116:119], v246 offset:34816
    v_mfma_f32_16x16x32_bf16 v[164:167], v[208:211], v[108:111], v[164:167]
    ds_read_b64_tr_b16 v[192:193], v248 offset:32768
    ds_read_b64_tr_b16 v[194:195], v248 offset:33792
    s_waitcnt lgkmcnt(8)
    v_mfma_f32_16x16x32_bf16 v[168:171], v[212:215], v[104:107], v[168:171]
    ds_read_b64_tr_b16 v[196:197], v249 offset:32768
    ds_read_b64_tr_b16 v[198:199], v249 offset:33792
    v_mfma_f32_16x16x32_bf16 v[172:175], v[212:215], v[108:111], v[172:175]
    ds_read_b64_tr_b16 v[200:201], v250 offset:32768
    ds_read_b64_tr_b16 v[202:203], v250 offset:33792
    s_add_u32 m0, s86, 32768
    s_mov_b32 s4, 1152
    buffer_load_dwordx4 v244, s[28:31], s4 offen lds
    s_waitcnt lgkmcnt(10)
    v_mfma_f32_16x16x32_bf16 v[176:179], v[216:219], v[104:107], v[176:179]
    ds_read_b64_tr_b16 v[204:205], v251 offset:32768
    ds_read_b64_tr_b16 v[206:207], v251 offset:33792
    v_mfma_f32_16x16x32_bf16 v[180:183], v[216:219], v[108:111], v[180:183]
    s_waitcnt lgkmcnt(10)
    v_mfma_f32_16x16x32_bf16 v[184:187], v[220:223], v[104:107], v[184:187]
    v_mfma_f32_16x16x32_bf16 v[188:191], v[220:223], v[108:111], v[188:191]
    s_add_u32 m0, s86, 49152
    s_mov_b32 s4, 1990656
    buffer_load_dwordx4 v245, s[40:43], s4 offen lds
    s_waitcnt lgkmcnt(6)
    v_mfma_f32_16x16x32_bf16 v[160:163], v[192:195], v[112:115], v[160:163]
    ds_read_b128 v[120:123], v247 offset:32768
    ds_read_b128 v[124:127], v247 offset:34816
    v_mfma_f32_16x16x32_bf16 v[164:167], v[192:195], v[116:119], v[164:167]
    ds_read_b64_tr_b16 v[208:209], v248 offset:40960
    ds_read_b64_tr_b16 v[210:211], v248 offset:41984
    s_waitcnt lgkmcnt(8)
    v_mfma_f32_16x16x32_bf16 v[168:171], v[196:199], v[112:115], v[168:171]
    ds_read_b64_tr_b16 v[212:213], v249 offset:40960
    ds_read_b64_tr_b16 v[214:215], v249 offset:41984
    v_mfma_f32_16x16x32_bf16 v[172:175], v[196:199], v[116:119], v[172:175]
    ds_read_b64_tr_b16 v[216:217], v250 offset:40960
    ds_read_b64_tr_b16 v[218:219], v250 offset:41984
    s_add_u32 m0, s86, 40960
    s_mov_b32 s4, 83072
    buffer_load_dwordx4 v244, s[28:31], s4 offen lds
    s_waitcnt lgkmcnt(10)
    v_mfma_f32_16x16x32_bf16 v[176:179], v[200:203], v[112:115], v[176:179]
    ds_read_b64_tr_b16 v[220:221], v251 offset:40960
    ds_read_b64_tr_b16 v[222:223], v251 offset:41984
    v_mfma_f32_16x16x32_bf16 v[180:183], v[200:203], v[116:119], v[180:183]
    s_waitcnt lgkmcnt(10)
    v_mfma_f32_16x16x32_bf16 v[184:187], v[204:207], v[112:115], v[184:187]
    v_mfma_f32_16x16x32_bf16 v[188:191], v[204:207], v[116:119], v[188:191]
    s_add_u32 m0, s86, 57344
    s_mov_b32 s4, 2101248
    buffer_load_dwordx4 v245, s[40:43], s4 offen lds
    s_waitcnt vmcnt(4)
    s_cmp_lg_u32 s76, 0
    s_cbranch_scc1 L_np7
    s_waitcnt vmcnt(4)
    s_mov_b32 s5, 20000
L_sp1:
    v_cmp_gt_u32 vcc, 128, v240
    s_nop 4
    s_cbranch_vccz L_ok1
    s_sub_u32 s5, s5, 1
    s_cbranch_scc1 L_ok1
    s_sleep 4
    buffer_load_dword v240, v241, s[64:67], 0 offen sc1
    s_waitcnt vmcnt(0)
    s_branch L_sp1
L_ok1:
L_np7:
    s_barrier
    s_lshl_b32 s4, s78, 7
    s_lshl_b32 s5, s76, 4
    s_add_u32 s4, s4, s5
    v_add_u32 v230, s4, v254
    v_lshlrev_b32 v231, 1, v230
    v_lshlrev_b32 v230, 2, v230
    v_lshl_add_u32 v230, v253, 15, v230
    v_lshlrev_b32 v232, 2, v253
    v_lshl_add_u32 v232, v254, 4, v232
    s_lshl_b32 s4, s77, 11
    s_lshl_b32 s5, s76, 8
    s_add_u32 s6, s4, s5
    s_add_u32 s6, s6, 15466496
    s_mov_b32 s4, 15499264
    buffer_load_dword v224, v230, s[68:71], s4 offen sc1
    s_mov_b32 s4, 15507456
    buffer_load_dword v225, v230, s[68:71], s4 offen sc1
    s_mov_b32 s4, 15515648
    buffer_load_dword v226, v230, s[68:71], s4 offen sc1
    s_mov_b32 s4, 15523840
    buffer_load_dword v227, v230, s[68:71], s4 offen sc1
    buffer_load_ushort v228, v231, s[44:47], 0 offen
    buffer_load_dword v229, v232, s[68:71], s6 offen sc1
    s_waitcnt lgkmcnt(6)
    v_mfma_f32_16x16x32_bf16 v[160:163], v[208:211], v[120:123], v[160:163]
    v_xor_b32 v246, 0x10000, v246
    v_xor_b32 v247, 0x10000, v247
    v_xor_b32 v248, 0x10000, v248
    v_xor_b32 v249, 0x10000, v249
    v_xor_b32 v250, 0x10000, v250
    v_xor_b32 v251, 0x10000, v251
    ds_read_b128 v[128:131], v246 offset:0
    v_mfma_f32_16x16x32_bf16 v[164:167], v[208:211], v[124:127], v[164:167]
    ds_read_b128 v[132:135], v246 offset:2048
    ds_read_b64_tr_b16 v[192:193], v248 offset:0
    s_waitcnt lgkmcnt(7)
    v_mfma_f32_16x16x32_bf16 v[168:171], v[212:215], v[120:123], v[168:171]
    ds_read_b64_tr_b16 v[194:195], v248 offset:1024
    ds_read_b64_tr_b16 v[196:197], v249 offset:0
    v_mfma_f32_16x16x32_bf16 v[172:175], v[212:215], v[124:127], v[172:175]
    ds_read_b64_tr_b16 v[198:199], v249 offset:1024
    ds_read_b64_tr_b16 v[200:201], v250 offset:0
    s_add_u32 m0, s86, 65536
    s_add_u32 s4, s87, 0
    buffer_load_dwordx4 v252, s[68:71], s4 offen sc1 lds
    s_waitcnt lgkmcnt(9)
    v_mfma_f32_16x16x32_bf16 v[176:179], v[216:219], v[120:123], v[176:179]
    ds_read_b64_tr_b16 v[202:203], v250 offset:1024
    ds_read_b64_tr_b16 v[204:205], v251 offset:0
    v_mfma_f32_16x16x32_bf16 v[180:183], v[216:219], v[124:127], v[180:183]
    ds_read_b64_tr_b16 v[206:207], v251 offset:1024
    s_waitcnt lgkmcnt(10)
    v_mfma_f32_16x16x32_bf16 v[184:187], v[220:223], v[120:123], v[184:187]
    v_mfma_f32_16x16x32_bf16 v[188:191], v[220:223], v[124:127], v[188:191]
    s_add_u32 m0, s86, 73728
    s_add_u32 s4, s87, 8192
    buffer_load_dwordx4 v252, s[68:71], s4 offen sc1 lds
    s_waitcnt lgkmcnt(6)
    v_mfma_f32_16x16x32_bf16 v[160:163], v[192:195], v[128:131], v[160:163]
    ds_read_b128 v[136:139], v247 offset:0
    ds_read_b128 v[140:143], v247 offset:2048
    v_mfma_f32_16x16x32_bf16 v[164:167], v[192:195], v[132:135], v[164:167]
    ds_read_b64_tr_b16 v[208:209], v248 offset:8192
    ds_read_b64_tr_b16 v[210:211], v248 offset:9216
    s_waitcnt lgkmcnt(8)
    v_mfma_f32_16x16x32_bf16 v[168:171], v[196:199], v[128:131], v[168:171]
    ds_read_b64_tr_b16 v[212:213], v249 offset:8192
    ds_read_b64_tr_b16 v[214:215], v249 offset:9216
    v_mfma_f32_16x16x32_bf16 v[172:175], v[196:199], v[132:135], v[172:175]
    ds_read_b64_tr_b16 v[216:217], v250 offset:8192
    ds_read_b64_tr_b16 v[218:219], v250 offset:9216
    s_add_u32 m0, s86, 81920
    s_add_u32 s4, s87, 16384
    buffer_load_dwordx4 v252, s[68:71], s4 offen sc1 lds
    s_waitcnt lgkmcnt(10)
    v_mfma_f32_16x16x32_bf16 v[176:179], v[200:203], v[128:131], v[176:179]
    ds_read_b64_tr_b16 v[220:221], v251 offset:8192
    ds_read_b64_tr_b16 v[222:223], v251 offset:9216
    v_mfma_f32_16x16x32_bf16 v[180:183], v[200:203], v[132:135], v[180:183]
    s_waitcnt lgkmcnt(10)
    v_mfma_f32_16x16x32_bf16 v[184:187], v[204:207], v[128:131], v[184:187]
    v_mfma_f32_16x16x32_bf16 v[188:191], v[204:207], v[132:135], v[188:191]
    s_add_u32 m0, s86, 90112
    s_add_u32 s4, s87, 24576
    buffer_load_dwordx4 v252, s[68:71], s4 offen sc1 lds
    s_waitcnt vmcnt(10)
    s_barrier
    s_waitcnt lgkmcnt(6)
    v_mfma_f32_16x16x32_bf16 v[160:163], v[208:211], v[136:139], v[160:163]
    ds_read_b128 v[144:147], v246 offset:32768
    ds_read_b128 v[148:151], v246 offset:34816
    v_mfma_f32_16x16x32_bf16 v[164:167], v[208:211], v[140:143], v[164:167]
    ds_read_b64_tr_b16 v[192:193], v248 offset:32768
    ds_read_b64_tr_b16 v[194:195], v248 offset:33792
    s_waitcnt lgkmcnt(8)
    v_mfma_f32_16x16x32_bf16 v[168:171], v[212:215], v[136:139], v[168:171]
    ds_read_b64_tr_b16 v[196:197], v249 offset:32768
    ds_read_b64_tr_b16 v[198:199], v249 offset:33792
    v_mfma_f32_16x16x32_bf16 v[172:175], v[212:215], v[140:143], v[172:175]
    ds_read_b64_tr_b16 v[200:201], v250 offset:32768
    ds_read_b64_tr_b16 v[202:203], v250 offset:33792
    s_add_u32 m0, s86, 98304
    s_add_u32 s4, s87, 32768
    buffer_load_dwordx4 v252, s[68:71], s4 offen sc1 lds
    s_waitcnt lgkmcnt(10)
    v_mfma_f32_16x16x32_bf16 v[176:179], v[216:219], v[136:139], v[176:179]
    ds_read_b64_tr_b16 v[204:205], v251 offset:32768
    ds_read_b64_tr_b16 v[206:207], v251 offset:33792
    v_mfma_f32_16x16x32_bf16 v[180:183], v[216:219], v[140:143], v[180:183]
    s_waitcnt lgkmcnt(10)
    v_mfma_f32_16x16x32_bf16 v[184:187], v[220:223], v[136:139], v[184:187]
    v_mfma_f32_16x16x32_bf16 v[188:191], v[220:223], v[140:143], v[188:191]
    s_add_u32 m0, s86, 106496
    s_add_u32 s4, s87, 40960
    buffer_load_dwordx4 v252, s[68:71], s4 offen sc1 lds
    s_waitcnt lgkmcnt(6)
    v_mfma_f32_16x16x32_bf16 v[160:163], v[192:195], v[144:147], v[160:163]
    ds_read_b128 v[152:155], v247 offset:32768
    ds_read_b128 v[156:159], v247 offset:34816
    v_mfma_f32_16x16x32_bf16 v[164:167], v[192:195], v[148:151], v[164:167]
    ds_read_b64_tr_b16 v[208:209], v248 offset:40960
    ds_read_b64_tr_b16 v[210:211], v248 offset:41984
    s_waitcnt lgkmcnt(8)
    v_mfma_f32_16x16x32_bf16 v[168:171], v[196:199], v[144:147], v[168:171]
    ds_read_b64_tr_b16 v[212:213], v249 offset:40960
    ds_read_b64_tr_b16 v[214:215], v249 offset:41984
    v_mfma_f32_16x16x32_bf16 v[172:175], v[196:199], v[148:151], v[172:175]
    ds_read_b64_tr_b16 v[216:217], v250 offset:40960
    ds_read_b64_tr_b16 v[218:219], v250 offset:41984
    s_add_u32 m0, s86, 114688
    s_add_u32 s4, s87, 49152
    buffer_load_dwordx4 v252, s[68:71], s4 offen sc1 lds
    s_waitcnt lgkmcnt(10)
    v_mfma_f32_16x16x32_bf16 v[176:179], v[200:203], v[144:147], v[176:179]
    ds_read_b64_tr_b16 v[220:221], v251 offset:40960
    ds_read_b64_tr_b16 v[222:223], v251 offset:41984
    v_mfma_f32_16x16x32_bf16 v[180:183], v[200:203], v[148:151], v[180:183]
    s_waitcnt lgkmcnt(10)
    v_mfma_f32_16x16x32_bf16 v[184:187], v[204:207], v[144:147], v[184:187]
    v_mfma_f32_16x16x32_bf16 v[188:191], v[204:207], v[148:151], v[188:191]
    s_add_u32 m0, s86, 122880
    s_add_u32 s4, s87, 57344
    buffer_load_dwordx4 v252, s[68:71], s4 offen sc1 lds
    s_waitcnt vmcnt(4)
    s_barrier
    s_waitcnt lgkmcnt(6)
    v_mfma_f32_16x16x32_bf16 v[160:163], v[208:211], v[152:155], v[160:163]
    v_mfma_f32_16x16x32_bf16 v[164:167], v[208:211], v[156:159], v[164:167]
    s_add_u32 m0, s86, 0
    s_add_u32 s4, s87, 65536
    buffer_load_dwordx4 v252, s[68:71], s4 offen sc1 lds
    s_waitcnt lgkmcnt(4)
    v_mfma_f32_16x16x32_bf16 v[168:171], v[212:215], v[152:155], v[168:171]
    v_mfma_f32_16x16x32_bf16 v[172:175], v[212:215], v[156:159], v[172:175]
    s_add_u32 m0, s86, 8192
    s_add_u32 s4, s87, 73728
    buffer_load_dwordx4 v252, s[68:71], s4 offen sc1 lds
    s_waitcnt lgkmcnt(2)
    v_mfma_f32_16x16x32_bf16 v[176:179], v[216:219], v[152:155], v[176:179]
    v_mfma_f32_16x16x32_bf16 v[180:183], v[216:219], v[156:159], v[180:183]
    s_add_u32 m0, s86, 16384
    s_add_u32 s4, s87, 81920
    buffer_load_dwordx4 v252, s[68:71], s4 offen sc1 lds
    s_waitcnt lgkmcnt(0)
    v_mfma_f32_16x16x32_bf16 v[184:187], v[220:223], v[152:155], v[184:187]
    v_mfma_f32_16x16x32_bf16 v[188:191], v[220:223], v[156:159], v[188:191]
    s_add_u32 m0, s86, 24576
    s_add_u32 s4, s87, 90112
    buffer_load_dwordx4 v252, s[68:71], s4 offen sc1 lds
    s_waitcnt vmcnt(12)
    v_add_f32 v224, v224, v225
    v_add_f32 v226, v226, v227
    v_lshlrev_b32 v228, 16, v228
    v_add_f32 v224, v224, v226
    v_mov_b32 v225, v224
    s_nop 1
    v_permlane16_swap_b32 v225, v224
    v_add_f32 v224, v224, v225
    v_mov_b32 v225, v224
    s_nop 1
    v_permlane32_swap_b32 v225, v224
    v_add_f32 v224, v224, v225
    s_lshl_b32 s4, s76, 6
    s_add_u32 s4, s4, 131072
    v_lshl_add_u32 v230, v254, 2, s4
    ds_write_b32 v230, v224
    ds_write_b32 v230, v228 offset:512
    s_lshl_b32 s4, s76, 8
    s_add_u32 s4, s4, 143360
    v_add_u32 v232, s4, v232
    ds_write_b32 v232, v229
    s_mov_b32 s8, 0xbdd2d3e8
    s_mov_b32 s9, s8
    s_mov_b32 s6, 1.0
    s_mov_b32 s7, 1.0
    s_lshl_b32 s4, s80, 8
    s_add_u32 s4, s4, 131072
    v_lshl_add_u32 v244, v253, 4, s4
    s_lshl_b32 s4, s79, 9
    s_add_u32 s4, s4, 143360
    v_lshl_add_u32 v245, v254, 4, s4
    v_add_u32 v246, 0x10000, v252
    s_lshl_b32 s4, s78, 1
    s_add_u32 s4, s4, s80
    s_cmp_lt_u32 s4, 27
    s_cselect_b32 s5, 0, 1073741824
    v_add_u32 v247, s5, v252
    s_lshl_b32 s4, s4, 11
    s_add_u32 s10, s88, s4
    s_mul_i32 s12, s82, 378880
    s_mul_i32 s4, s79, 5120
    s_add_u32 s12, s12, s4
    s_add_u32 s12, s12, 2621440
    s_mul_i32 s13, s81, 303104
    s_lshl_b32 s4, s79, 10
    s_add_u32 s13, s13, s4
    s_add_u32 s13, s13, 5767168
    v_mov_b32 v248, 0xc0135761
    v_mov_b32 v249, v248
    s_waitcnt lgkmcnt(0)
    s_cmp_lg_u32 s80, 0
    s_cbranch_scc1 L_roleB
    s_lshr_b32 s14, s81, 1
    s_lshl_b32 s14, s14, 8
    s_add_u32 s14, s14, 15695872
    s_cmp_lt_u32 s79, 2
    s_cselect_b32 s4, 0, 1073741824
    v_add_u32 v250, s4, v252
    v_mov_b32 v251, 0
    s_waitcnt vmcnt(4)
    s_barrier
    ds_read_b128 v[232:235], v246 offset:0
    ds_read_b128 v[236:239], v246 offset:1024
    ds_read_b128 v[240:243], v246 offset:2048
    s_waitcnt lgkmcnt(2)
    v_mfma_f32_16x16x32_bf16 v[192:195], v[0:3], v[232:235], 0
    v_mfma_f32_16x16x32_bf16 v[196:199], v[4:7], v[232:235], 0
    ds_read_b128 v[232:235], v246 offset:3072
    s_waitcnt lgkmcnt(2)
    v_mfma_f32_16x16x32_bf16 v[200:203], v[0:3], v[236:239], 0
    v_mfma_f32_16x16x32_bf16 v[204:207], v[4:7], v[236:239], 0
    ds_read_b128 v[236:239], v246 offset:4096
    s_waitcnt lgkmcnt(2)
    v_mfma_f32_16x16x32_bf16 v[208:211], v[0:3], v[240:243], 0
    v_mfma_f32_16x16x32_bf16 v[212:215], v[4:7], v[240:243], 0
    ds_read_b128 v[240:243], v246 offset:8192
    s_waitcnt lgkmcnt(2)
    v_mfma_f32_16x16x32_bf16 v[216:219], v[0:3], v[232:235], 0
    v_mfma_f32_16x16x32_bf16 v[220:223], v[4:7], v[232:235], 0
    ds_read_b128 v[232:235], v246 offset:9216
    s_waitcnt lgkmcnt(2)
    v_mfma_f32_16x16x32_bf16 v[224:227], v[0:3], v[236:239], 0
    v_mfma_f32_16x16x32_bf16 v[228:231], v[4:7], v[236:239], 0
    s_add_u32 m0, s86, 32768
    s_add_u32 s4, s87, 98304
    buffer_load_dwordx4 v252, s[68:71], s4 offen sc1 lds
    ds_read_b128 v[236:239], v246 offset:10240
    ds_read_b128 v[0:3], v246 offset:11264
    ds_read_b128 v[4:7], v246 offset:12288
    s_waitcnt lgkmcnt(4)
    v_mfma_f32_16x16x32_bf16 v[192:195], v[8:11], v[240:243], v[192:195]
    v_mfma_f32_16x16x32_bf16 v[196:199], v[12:15], v[240:243], v[196:199]
    ds_read_b128 v[240:243], v246 offset:16384
    s_waitcnt lgkmcnt(4)
    v_mfma_f32_16x16x32_bf16 v[200:203], v[8:11], v[232:235], v[200:203]
    v_mfma_f32_16x16x32_bf16 v[204:207], v[12:15], v[232:235], v[204:207]
    ds_read_b128 v[232:235], v246 offset:17408
    s_waitcnt lgkmcnt(4)
    v_mfma_f32_16x16x32_bf16 v[208:211], v[8:11], v[236:239], v[208:211]
    v_mfma_f32_16x16x32_bf16 v[212:215], v[12:15], v[236:239], v[212:215]
    ds_read_b128 v[236:239], v246 offset:18432
    s_waitcnt lgkmcnt(4)
    v_mfma_f32_16x16x32_bf16 v[216:219], v[8:11], v[0:3], v[216:219]
    v_mfma_f32_16x16x32_bf16 v[220:223], v[12:15], v[0:3], v[220:223]
    ds_read_b128 v[0:3], v246 offset:19456
    s_waitcnt lgkmcnt(4)
    v_mfma_f32_16x16x32_bf16 v[224:227], v[8:11], v[4:7], v[224:227]
    v_mfma_f32_16x16x32_bf16 v[228:231], v[12:15], v[4:7], v[228:231]
    s_add_u32 m0, s86, 40960
    s_add_u32 s4, s87, 106496
    buffer_load_dwordx4 v252, s[68:71], s4 offen sc1 lds
    ds_read_b128 v[4:7], v246 offset:20480
    s_waitcnt lgkmcnt(4)
    v_mfma_f32_16x16x32_bf16 v[192:195], v[16:19], v[240:243], v[192:195]
    v_mfma_f32_16x16x32_bf16 v[196:199], v[20:23], v[240:243], v[196:199]
    ds_read_b128 v[240:243], v246 offset:24576
    s_waitcnt lgkmcnt(4)
    v_mfma_f32_16x16x32_bf16 v[200:203], v[16:19], v[232:235], v[200:203]
    v_mfma_f32_16x16x32_bf16 v[204:207], v[20:23], v[232:235], v[204:207]
    ds_read_b128 v[232:235], v246 offset:25600
    s_waitcnt lgkmcnt(4)
    v_mfma_f32_16x16x32_bf16 v[208:211], v[16:19], v[236:239], v[208:211]
    v_mfma_f32_16x16x32_bf16 v[212:215], v[20:23], v[236:239], v[212:215]
    ds_read_b128 v[236:239], v246 offset:26624
    s_waitcnt lgkmcnt(4)
    v_mfma_f32_16x16x32_bf16 v[216:219], v[16:19], v[0:3], v[216:219]
    v_mfma_f32_16x16x32_bf16 v[220:223], v[20:23], v[0:3], v[220:223]
    ds_read_b128 v[0:3], v246 offset:27648
    s_waitcnt lgkmcnt(4)
    v_mfma_f32_16x16x32_bf16 v[224:227], v[16:19], v[4:7], v[224:227]
    v_mfma_f32_16x16x32_bf16 v[228:231], v[20:23], v[4:7], v[228:231]
    s_add_u32 m0, s86, 49152
    s_add_u32 s4, s87, 114688
    buffer_load_dwordx4 v252, s[68:71], s4 offen sc1 lds
    ds_read_b128 v[4:7], v246 offset:28672
    s_waitcnt lgkmcnt(4)
    v_mfma_f32_16x16x32_bf16 v[192:195], v[24:27], v[240:243], v[192:195]
    v_mfma_f32_16x16x32_bf16 v[196:199], v[28:31], v[240:243], v[196:199]
    ds_read_b128 v[240:243], v246 offset:32768
    s_waitcnt lgkmcnt(4)
    v_mfma_f32_16x16x32_bf16 v[200:203], v[24:27], v[232:235], v[200:203]
    v_mfma_f32_16x16x32_bf16 v[204:207], v[28:31], v[232:235], v[204:207]
    ds_read_b128 v[232:235], v246 offset:33792
    s_waitcnt lgkmcnt(4)
    v_mfma_f32_16x16x32_bf16 v[208:211], v[24:27], v[236:239], v[208:211]
    v_mfma_f32_16x16x32_bf16 v[212:215], v[28:31], v[236:239], v[212:215]
    ds_read_b128 v[236:239], v246 offset:34816
    s_waitcnt lgkmcnt(4)
    v_mfma_f32_16x16x32_bf16 v[216:219], v[24:27], v[0:3], v[216:219]
    v_mfma_f32_16x16x32_bf16 v[220:223], v[28:31], v[0:3], v[220:223]
    ds_read_b128 v[0:3], v246 offset:35840
    s_waitcnt lgkmcnt(4)
    v_mfma_f32_16x16x32_bf16 v[224:227], v[24:27], v[4:7], v[224:227]
    v_mfma_f32_16x16x32_bf16 v[228:231], v[28:31], v[4:7], v[228:231]
    s_add_u32 m0, s86, 57344
    s_add_u32 s4, s87, 122880
    buffer_load_dwordx4 v252, s[68:71], s4 offen sc1 lds
    s_waitcnt vmcnt(4)
    s_barrier
    ds_read_b128 v[4:7], v246 offset:36864
    ds_read_b128 v[8:11], v244 offset:0
    ds_read_b128 v[16:19], v244 offset:512
    ds_read_b128 v[12:15], v244 offset:64
    ds_read_b128 v[20:23], v244 offset:576
    ds_read_b128 v[24:27], v245 offset:0
    s_waitcnt lgkmcnt(9)
    v_mfma_f32_16x16x32_bf16 v[192:195], v[32:35], v[240:243], v[192:195]
    v_mfma_f32_16x16x32_bf16 v[196:199], v[36:39], v[240:243], v[196:199]
    ds_read_b128 v[240:243], v246 offset:40960
    s_waitcnt lgkmcnt(1)
    v_fmac_f32 v16, v8, v25
    v_fmac_f32 v17, v9, v25
    v_fmac_f32 v18, v10, v25
    v_fmac_f32 v19, v11, v25
    v_fmac_f32 v20, v12, v25
    v_mfma_f32_16x16x32_bf16 v[200:203], v[32:35], v[232:235], v[200:203]
    v_mfma_f32_16x16x32_bf16 v[204:207], v[36:39], v[232:235], v[204:207]
    ds_read_b128 v[232:235], v246 offset:41984
    v_fmac_f32 v21, v13, v25
    v_fmac_f32 v22, v14, v25
    v_fmac_f32 v23, v15, v25
    v_fmac_f32 v16, v160, v24
    v_fmac_f32 v17, v161, v24
    v_fmac_f32 v18, v162, v24
    v_mfma_f32_16x16x32_bf16 v[208:211], v[32:35], v[236:239], v[208:211]
    v_mfma_f32_16x16x32_bf16 v[212:215], v[36:39], v[236:239], v[212:215]
    ds_read_b128 v[236:239], v246 offset:43008
    v_fmac_f32 v19, v163, v24
    v_fmac_f32 v20, v168, v24
    v_fmac_f32 v21, v169, v24
    v_fmac_f32 v22, v170, v24
    v_fmac_f32 v23, v171, v24
    v_mul_f32 v8, v16, v16
    v_mfma_f32_16x16x32_bf16 v[216:219], v[32:35], v[0:3], v[216:219]
    v_mfma_f32_16x16x32_bf16 v[220:223], v[36:39], v[0:3], v[220:223]
    ds_read_b128 v[0:3], v246 offset:44032
    v_mul_f32 v9, v17, v17
    v_mul_f32 v10, v18, v18
    v_mul_f32 v11, v19, v19
    v_mul_f32 v12, v20, v20
    v_mul_f32 v13, v21, v21
    v_mul_f32 v14, v22, v22
    v_mfma_f32_16x16x32_bf16 v[224:227], v[32:35], v[4:7], v[224:227]
    v_mfma_f32_16x16x32_bf16 v[228:231], v[36:39], v[4:7], v[228:231]
    s_add_u32 m0, s86, 65536
    s_add_u32 s4, s87, 131072
    buffer_load_dwordx4 v252, s[68:71], s4 offen sc1 lds
    ds_read_b128 v[4:7], v246 offset:45056
    ds_read_b128 v[32:35], v246 offset:49152
    v_mul_f32 v15, v23, v23
    v_fma_f32 v8, v8, s8, v248
    v_fma_f32 v9, v9, s8, v248
    v_fma_f32 v10, v10, s8, v248
    v_fma_f32 v11, v11, s8, v248
    v_fma_f32 v12, v12, s8, v248
    s_waitcnt lgkmcnt(5)
    v_mfma_f32_16x16x32_bf16 v[192:195], v[40:43], v[240:243], v[192:195]
    v_mfma_f32_16x16x32_bf16 v[196:199], v[44:47], v[240:243], v[196:199]
    ds_read_b128 v[36:39], v246 offset:50176
    v_fma_f32 v13, v13, s8, v248
    v_fma_f32 v14, v14, s8, v248
    v_fma_f32 v15, v15, s8, v248
    v_mul_f32 v8, v8, v16
    v_mul_f32 v9, v9, v17
    v_mul_f32 v10, v10, v18
    s_waitcnt lgkmcnt(5)
    v_mfma_f32_16x16x32_bf16 v[200:203], v[40:43], v[232:235], v[200:203]
    v_mfma_f32_16x16x32_bf16 v[204:207], v[44:47], v[232:235], v[204:207]
    ds_read_b128 v[240:243], v246 offset:51200
    v_mul_f32 v11, v11, v19
    v_mul_f32 v12, v12, v20
    v_mul_f32 v13, v13, v21
    v_mul_f32 v14, v14, v22
    v_mul_f32 v15, v15, v23
    v_exp_f32 v8, v8
    s_waitcnt lgkmcnt(5)
    v_mfma_f32_16x16x32_bf16 v[208:211], v[40:43], v[236:239], v[208:211]
    v_mfma_f32_16x16x32_bf16 v[212:215], v[44:47], v[236:239], v[212:215]
    ds_read_b128 v[232:235], v246 offset:52224
    v_exp_f32 v9, v9
    v_exp_f32 v10, v10
    v_exp_f32 v11, v11
    v_exp_f32 v12, v12
    v_exp_f32 v13, v13
    v_exp_f32 v14, v14
    s_waitcnt lgkmcnt(5)
    v_mfma_f32_16x16x32_bf16 v[216:219], v[40:43], v[0:3], v[216:219]
    v_mfma_f32_16x16x32_bf16 v[220:223], v[44:47], v[0:3], v[220:223]
    ds_read_b128 v[236:239], v246 offset:53248
    v_exp_f32 v15, v15
    v_fma_f32 v8, v8, v27, v27
    v_fma_f32 v9, v9, v27, v27
    v_fma_f32 v10, v10, v27, v27
    v_fma_f32 v11, v11, v27, v27
    v_fma_f32 v12, v12, v27, v27
    s_waitcnt lgkmcnt(5)
    v_mfma_f32_16x16x32_bf16 v[224:227], v[40:43], v[4:7], v[224:227]
    v_mfma_f32_16x16x32_bf16 v[228:231], v[44:47], v[4:7], v[228:231]
    s_add_u32 m0, s86, 73728
    s_add_u32 s4, s87, 139264
    buffer_load_dwordx4 v252, s[68:71], s4 offen sc1 lds
    ds_read_b128 v[0:3], v246 offset:57344
    v_fma_f32 v13, v13, v27, v27
    v_fma_f32 v14, v14, v27, v27
    v_fma_f32 v15, v15, v27, v27
    v_rcp_f32 v8, v8
    v_rcp_f32 v9, v9
    v_rcp_f32 v10, v10
    s_waitcnt lgkmcnt(5)
    v_mfma_f32_16x16x32_bf16 v[192:195], v[48:51], v[32:35], v[192:195]
    v_mfma_f32_16x16x32_bf16 v[196:199], v[52:55], v[32:35], v[196:199]
    ds_read_b128 v[4:7], v246 offset:58368
    v_rcp_f32 v11, v11
    v_rcp_f32 v12, v12
    v_rcp_f32 v13, v13
    v_rcp_f32 v14, v14
    v_rcp_f32 v15, v15
    v_mul_f32 v16, v16, v8
    s_waitcnt lgkmcnt(5)
    v_mfma_f32_16x16x32_bf16 v[200:203], v[48:51], v[36:39], v[200:203]
    v_mfma_f32_16x16x32_bf16 v[204:207], v[52:55], v[36:39], v[204:207]
    ds_read_b128 v[32:35], v246 offset:59392
    v_mul_f32 v17, v17, v9
    v_mul_f32 v18, v18, v10
    v_mul_f32 v19, v19, v11
    v_mul_f32 v20, v20, v12
    v_mul_f32 v21, v21, v13
    v_mul_f32 v22, v22, v14
    s_waitcnt lgkmcnt(5)
    v_mfma_f32_16x16x32_bf16 v[208:211], v[48:51], v[240:243], v[208:211]
    v_mfma_f32_16x16x32_bf16 v[212:215], v[52:55], v[240:243], v[212:215]
    ds_read_b128 v[36:39], v246 offset:60416
    v_mul_f32 v23, v23, v15
    v_cvt_pk_bf16_f32 v160, v16, v17
    v_cvt_pk_bf16_f32 v161, v18, v19
    v_cvt_pk_bf16_f32 v162, v20, v21
    v_cvt_pk_bf16_f32 v163, v22, v23
    s_add_u32 s5, s10, 0
    buffer_store_dwordx4 v[160:163], v247, s[68:71], s5 offen offset:0 sc1
    s_waitcnt lgkmcnt(5)
    v_mfma_f32_16x16x32_bf16 v[216:219], v[48:51], v[232:235], v[216:219]
    v_mfma_f32_16x16x32_bf16 v[220:223], v[52:55], v[232:235], v[220:223]
    ds_read_b128 v[240:243], v246 offset:61440
    ds_read_b128 v[8:11], v244 offset:0
    ds_read_b128 v[16:19], v244 offset:512
    ds_read_b128 v[12:15], v244 offset:64
    ds_read_b128 v[20:23], v244 offset:576
    ds_read_b128 v[24:27], v245 offset:256
    s_waitcnt lgkmcnt(10)
    v_mfma_f32_16x16x32_bf16 v[224:227], v[48:51], v[236:239], v[224:227]
    v_mfma_f32_16x16x32_bf16 v[228:231], v[52:55], v[236:239], v[228:231]
    s_add_u32 m0, s86, 81920
    s_add_u32 s4, s87, 147456
    buffer_load_dwordx4 v252, s[68:71], s4 offen sc1 lds
    ds_read_b128 v[232:235], v252 offset:0
    s_waitcnt lgkmcnt(1)
    v_fmac_f32 v16, v8, v25
    v_fmac_f32 v17, v9, v25
    v_fmac_f32 v18, v10, v25
    v_fmac_f32 v19, v11, v25
    v_fmac_f32 v20, v12, v25
    v_mfma_f32_16x16x32_bf16 v[192:195], v[56:59], v[0:3], v[192:195]
    v_mfma_f32_16x16x32_bf16 v[196:199], v[60:63], v[0:3], v[196:199]
    ds_read_b128 v[236:239], v252 offset:1024
    v_fmac_f32 v21, v13, v25
    v_fmac_f32 v22, v14, v25
    v_fmac_f32 v23, v15, v25
    v_fmac_f32 v16, v164, v24
    v_fmac_f32 v17, v165, v24
    v_fmac_f32 v18, v166, v24
    v_mfma_f32_16x16x32_bf16 v[200:203], v[56:59], v[4:7], v[200:203]
    v_mfma_f32_16x16x32_bf16 v[204:207], v[60:63], v[4:7], v[204:207]
    ds_read_b128 v[0:3], v252 offset:2048
    v_fmac_f32 v19, v167, v24
    v_fmac_f32 v20, v172, v24
    v_fmac_f32 v21, v173, v24
    v_fmac_f32 v22, v174, v24
    v_fmac_f32 v23, v175, v24
    v_mul_f32 v8, v16, v16
    v_mfma_f32_16x16x32_bf16 v[208:211], v[56:59], v[32:35], v[208:211]
    v_mfma_f32_16x16x32_bf16 v[212:215], v[60:63], v[32:35], v[212:215]
    ds_read_b128 v[4:7], v252 offset:3072
    v_mul_f32 v9, v17, v17
    v_mul_f32 v10, v18, v18
    v_mul_f32 v11, v19, v19
    v_mul_f32 v12, v20, v20
    v_mul_f32 v13, v21, v21
    v_mul_f32 v14, v22, v22
    v_mfma_f32_16x16x32_bf16 v[216:219], v[56:59], v[36:39], v[216:219]
    v_mfma_f32_16x16x32_bf16 v[220:223], v[60:63], v[36:39], v[220:223]
    ds_read_b128 v[32:35], v252 offset:4096
    v_mul_f32 v15, v23, v23
    v_fma_f32 v8, v8, s8, v248
    v_fma_f32 v9, v9, s8, v248
    v_fma_f32 v10, v10, s8, v248
    v_fma_f32 v11, v11, s8, v248
    v_fma_f32 v12, v12, s8, v248
    v_mfma_f32_16x16x32_bf16 v[224:227], v[56:59], v[240:243], v[224:227]
    v_mfma_f32_16x16x32_bf16 v[228:231], v[60:63], v[240:243], v[228:231]
    s_add_u32 m0, s86, 90112
    s_add_u32 s4, s87, 155648
    buffer_load_dwordx4 v252, s[68:71], s4 offen sc1 lds
    s_waitcnt vmcnt(5)
    s_barrier
    ds_read_b128 v[36:39], v252 offset:8192
    v_fma_f32 v13, v13, s8, v248
    v_fma_f32 v14, v14, s8, v248
    v_fma_f32 v15, v15, s8, v248
    v_mul_f32 v8, v8, v16
    v_mul_f32 v9, v9, v17
    v_mul_f32 v10, v10, v18
    s_waitcnt lgkmcnt(5)
    v_mfma_f32_16x16x32_bf16 v[192:195], v[64:67], v[232:235], v[192:195]
    v_mfma_f32_16x16x32_bf16 v[196:199], v[68:71], v[232:235], v[196:199]
    ds_read_b128 v[240:243], v252 offset:9216
    v_mul_f32 v11, v11, v19
    v_mul_f32 v12, v12, v20
    v_mul_f32 v13, v13, v21
    v_mul_f32 v14, v14, v22
    v_mul_f32 v15, v15, v23
    v_exp_f32 v8, v8
    s_waitcnt lgkmcnt(5)
    v_mfma_f32_16x16x32_bf16 v[200:203], v[64:67], v[236:239], v[200:203]
    v_mfma_f32_16x16x32_bf16 v[204:207], v[68:71], v[236:239], v[204:207]
    ds_read_b128 v[232:235], v252 offset:10240
    v_exp_f32 v9, v9
    v_exp_f32 v10, v10
    v_exp_f32 v11, v11
    v_exp_f32 v12, v12
    v_exp_f32 v13, v13
    v_exp_f32 v14, v14
    s_waitcnt lgkmcnt(5)
    v_mfma_f32_16x16x32_bf16 v[208:211], v[64:67], v[0:3], v[208:211]
    v_mfma_f32_16x16x32_bf16 v[212:215], v[68:71], v[0:3], v[212:215]
    ds_read_b128 v[236:239], v252 offset:11264
    v_exp_f32 v15, v15
    v_fma_f32 v8, v8, v27, v27
    v_fma_f32 v9, v9, v27, v27
    v_fma_f32 v10, v10, v27, v27
    v_fma_f32 v11, v11, v27, v27
    v_fma_f32 v12, v12, v27, v27
    s_waitcnt lgkmcnt(5)
    v_mfma_f32_16x16x32_bf16 v[216:219], v[64:67], v[4:7], v[216:219]
    v_mfma_f32_16x16x32_bf16 v[220:223], v[68:71], v[4:7], v[220:223]
    ds_read_b128 v[0:3], v252 offset:12288
    v_fma_f32 v13, v13, v27, v27
    v_fma_f32 v14, v14, v27, v27
    v_fma_f32 v15, v15, v27, v27
    v_rcp_f32 v8, v8
    v_rcp_f32 v9, v9
    v_rcp_f32 v10, v10
    s_waitcnt lgkmcnt(5)
    v_mfma_f32_16x16x32_bf16 v[224:227], v[64:67], v[32:35], v[224:227]
    v_mfma_f32_16x16x32_bf16 v[228:231], v[68:71], v[32:35], v[228:231]
    ds_read_b128 v[4:7], v252 offset:16384
    v_rcp_f32 v11, v11
    v_rcp_f32 v12, v12
    v_rcp_f32 v13, v13
    v_rcp_f32 v14, v14
    v_rcp_f32 v15, v15
    v_mul_f32 v16, v16, v8
    s_waitcnt lgkmcnt(5)
    v_mfma_f32_16x16x32_bf16 v[192:195], v[72:75], v[36:39], v[192:195]
    v_mfma_f32_16x16x32_bf16 v[196:199], v[76:79], v[36:39], v[196:199]
    ds_read_b128 v[32:35], v252 offset:17408
    v_mul_f32 v17, v17, v9
    v_mul_f32 v18, v18, v10
    v_mul_f32 v19, v19, v11
    v_mul_f32 v20, v20, v12
    v_mul_f32 v21, v21, v13
    v_mul_f32 v22, v22, v14
    s_waitcnt lgkmcnt(5)
    v_mfma_f32_16x16x32_bf16 v[200:203], v[72:75], v[240:243], v[200:203]
    v_mfma_f32_16x16x32_bf16 v[204:207], v[76:79], v[240:243], v[204:207]
    ds_read_b128 v[36:39], v252 offset:18432
    v_mul_f32 v23, v23, v15
    v_cvt_pk_bf16_f32 v164, v16, v17
    v_cvt_pk_bf16_f32 v165, v18, v19
    v_cvt_pk_bf16_f32 v166, v20, v21
    v_cvt_pk_bf16_f32 v167, v22, v23
    s_add_u32 s5, s10, 75776
    buffer_store_dwordx4 v[164:167], v247, s[68:71], s5 offen offset:0 sc1
    s_waitcnt lgkmcnt(5)
    v_mfma_f32_16x16x32_bf16 v[208:211], v[72:75], v[232:235], v[208:211]
    v_mfma_f32_16x16x32_bf16 v[212:215], v[76:79], v[232:235], v[212:215]
    ds_read_b128 v[240:243], v252 offset:19456
    ds_read_b128 v[8:11], v244 offset:128
    ds_read_b128 v[16:19], v244 offset:640
    ds_read_b128 v[12:15], v244 offset:192
    ds_read_b128 v[20:23], v244 offset:704
    ds_read_b128 v[24:27], v245 offset:0
    s_waitcnt lgkmcnt(10)
    v_mfma_f32_16x16x32_bf16 v[216:219], v[72:75], v[236:239], v[216:219]
    v_mfma_f32_16x16x32_bf16 v[220:223], v[76:79], v[236:239], v[220:223]
    ds_read_b128 v[232:235], v252 offset:20480
    s_waitcnt lgkmcnt(1)
    v_fmac_f32 v16, v8, v25
    v_fmac_f32 v17, v9, v25
    v_fmac_f32 v18, v10, v25
    v_fmac_f32 v19, v11, v25
    v_fmac_f32 v20, v12, v25
    v_mfma_f32_16x16x32_bf16 v[224:227], v[72:75], v[0:3], v[224:227]
    v_mfma_f32_16x16x32_bf16 v[228:231], v[76:79], v[0:3], v[228:231]
    ds_read_b128 v[236:239], v252 offset:24576
    v_fmac_f32 v21, v13, v25
    v_fmac_f32 v22, v14, v25
    v_fmac_f32 v23, v15, v25
    v_fmac_f32 v16, v176, v24
    v_fmac_f32 v17, v177, v24
    v_fmac_f32 v18, v178, v24
    v_mfma_f32_16x16x32_bf16 v[192:195], v[80:83], v[4:7], v[192:195]
    v_mfma_f32_16x16x32_bf16 v[196:199], v[84:87], v[4:7], v[196:199]
    ds_read_b128 v[0:3], v252 offset:25600
    v_fmac_f32 v19, v179, v24
    v_fmac_f32 v20, v184, v24
    v_fmac_f32 v21, v185, v24
    v_fmac_f32 v22, v186, v24
    v_fmac_f32 v23, v187, v24
    v_mul_f32 v8, v16, v16
    v_mfma_f32_16x16x32_bf16 v[200:203], v[80:83], v[32:35], v[200:203]
    v_mfma_f32_16x16x32_bf16 v[204:207], v[84:87], v[32:35], v[204:207]
    ds_read_b128 v[4:7], v252 offset:26624
    v_mul_f32 v9, v17, v17
    v_mul_f32 v10, v18, v18
    v_mul_f32 v11, v19, v19
    v_mul_f32 v12, v20, v20
    v_mul_f32 v13, v21, v21
    v_mul_f32 v14, v22, v22
    v_mfma_f32_16x16x32_bf16 v[208:211], v[80:83], v[36:39], v[208:211]
    v_mfma_f32_16x16x32_bf16 v[212:215], v[84:87], v[36:39], v[212:215]
    ds_read_b128 v[32:35], v252 offset:27648
    v_mul_f32 v15, v23, v23
    v_fma_f32 v8, v8, s8, v248
    v_fma_f32 v9, v9, s8, v248
    v_fma_f32 v10, v10, s8, v248
    v_fma_f32 v11, v11, s8, v248
    v_fma_f32 v12, v12, s8, v248
    v_mfma_f32_16x16x32_bf16 v[216:219], v[80:83], v[240:243], v[216:219]
    v_mfma_f32_16x16x32_bf16 v[220:223], v[84:87], v[240:243], v[220:223]
    ds_read_b128 v[36:39], v252 offset:28672
    v_fma_f32 v13, v13, s8, v248
    v_fma_f32 v14, v14, s8, v248
    v_fma_f32 v15, v15, s8, v248
    v_mul_f32 v8, v8, v16
    v_mul_f32 v9, v9, v17
    v_mul_f32 v10, v10, v18
    s_waitcnt lgkmcnt(5)
    v_mfma_f32_16x16x32_bf16 v[224:227], v[80:83], v[232:235], v[224:227]
    v_mfma_f32_16x16x32_bf16 v[228:231], v[84:87], v[232:235], v[228:231]
    s_add_u32 s17, s12, 0
    buffer_load_dwordx4 v[80:83], v252, s[68:71], s17 offen offset:0 sc1
    buffer_load_dwordx4 v[84:87], v252, s[68:71], s17 offen offset:1024 sc1
    ds_read_b128 v[240:243], v252 offset:32768
    v_mul_f32 v11, v11, v19
    v_mul_f32 v12, v12, v20
    v_mul_f32 v13, v13, v21
    v_mul_f32 v14, v14, v22
    v_mul_f32 v15, v15, v23
    v_exp_f32 v8, v8
    s_waitcnt lgkmcnt(5)
    v_mfma_f32_16x16x32_bf16 v[192:195], v[88:91], v[236:239], v[192:195]
    v_mfma_f32_16x16x32_bf16 v[196:199], v[92:95], v[236:239], v[196:199]
    ds_read_b128 v[232:235], v252 offset:33792
    v_exp_f32 v9, v9
    v_exp_f32 v10, v10
    v_exp_f32 v11, v11
    v_exp_f32 v12, v12
    v_exp_f32 v13, v13
    v_exp_f32 v14, v14
    s_waitcnt lgkmcnt(5)
    v_mfma_f32_16x16x32_bf16 v[200:203], v[88:91], v[0:3], v[200:203]
    v_mfma_f32_16x16x32_bf16 v[204:207], v[92:95], v[0:3], v[204:207]
    ds_read_b128 v[236:239], v252 offset:34816
    v_exp_f32 v15, v15
    v_fma_f32 v8, v8, v27, v27
    v_fma_f32 v9, v9, v27, v27
    v_fma_f32 v10, v10, v27, v27
    v_fma_f32 v11, v11, v27, v27
    v_fma_f32 v12, v12, v27, v27
    s_waitcnt lgkmcnt(5)
    v_mfma_f32_16x16x32_bf16 v[208:211], v[88:91], v[4:7], v[208:211]
    v_mfma_f32_16x16x32_bf16 v[212:215], v[92:95], v[4:7], v[212:215]
    ds_read_b128 v[0:3], v252 offset:35840
    v_fma_f32 v13, v13, v27, v27
    v_fma_f32 v14, v14, v27, v27
    v_fma_f32 v15, v15, v27, v27
    v_rcp_f32 v8, v8
    v_rcp_f32 v9, v9
    v_rcp_f32 v10, v10
    s_waitcnt lgkmcnt(5)
    v_mfma_f32_16x16x32_bf16 v[216:219], v[88:91], v[32:35], v[216:219]
    v_mfma_f32_16x16x32_bf16 v[220:223], v[92:95], v[32:35], v[220:223]
    ds_read_b128 v[4:7], v252 offset:36864
    v_rcp_f32 v11, v11
    v_rcp_f32 v12, v12
    v_rcp_f32 v13, v13
    v_rcp_f32 v14, v14
    v_rcp_f32 v15, v15
    v_mul_f32 v16, v16, v8
    s_waitcnt lgkmcnt(5)
    v_mfma_f32_16x16x32_bf16 v[224:227], v[88:91], v[36:39], v[224:227]
    v_mfma_f32_16x16x32_bf16 v[228:231], v[92:95], v[36:39], v[228:231]
    buffer_load_dwordx4 v[88:91], v252, s[68:71], s17 offen offset:2048 sc1
    buffer_load_dwordx4 v[92:95], v252, s[68:71], s17 offen offset:3072 sc1
    s_waitcnt vmcnt(5)
    s_barrier
    ds_read_b128 v[32:35], v252 offset:40960
    v_mul_f32 v17, v17, v9
    v_mul_f32 v18, v18, v10
    v_mul_f32 v19, v19, v11
    v_mul_f32 v20, v20, v12
    v_mul_f32 v21, v21, v13
    v_mul_f32 v22, v22, v14
    s_waitcnt lgkmcnt(5)
    v_mfma_f32_16x16x32_bf16 v[192:195], v[96:99], v[240:243], v[192:195]
    v_mfma_f32_16x16x32_bf16 v[196:199], v[100:103], v[240:243], v[196:199]
    ds_read_b128 v[36:39], v252 offset:41984
    v_mul_f32 v23, v23, v15
    v_cvt_pk_bf16_f32 v176, v16, v17
    v_cvt_pk_bf16_f32 v177, v18, v19
    v_cvt_pk_bf16_f32 v178, v20, v21
    v_cvt_pk_bf16_f32 v179, v22, v23
    s_add_u32 s5, s10, 0
    buffer_store_dwordx4 v[176:179], v247, s[68:71], s5 offen offset:1024 sc1
    s_waitcnt lgkmcnt(5)
    v_mfma_f32_16x16x32_bf16 v[200:203], v[96:99], v[232:235], v[200:203]
    v_mfma_f32_16x16x32_bf16 v[204:207], v[100:103], v[232:235], v[204:207]
    ds_read_b128 v[240:243], v252 offset:43008
    ds_read_b128 v[8:11], v244 offset:128
    ds_read_b128 v[16:19], v244 offset:640
    ds_read_b128 v[12:15], v244 offset:192
    ds_read_b128 v[20:23], v244 offset:704
    ds_read_b128 v[24:27], v245 offset:256
    s_waitcnt lgkmcnt(10)
    v_mfma_f32_16x16x32_bf16 v[208:211], v[96:99], v[236:239], v[208:211]
    v_mfma_f32_16x16x32_bf16 v[212:215], v[100:103], v[236:239], v[212:215]
    ds_read_b128 v[232:235], v252 offset:44032
    s_waitcnt lgkmcnt(1)
    v_fmac_f32 v16, v8, v25
    v_fmac_f32 v17, v9, v25
    v_fmac_f32 v18, v10, v25
    v_fmac_f32 v19, v11, v25
    v_fmac_f32 v20, v12, v25
    v_mfma_f32_16x16x32_bf16 v[216:219], v[96:99], v[0:3], v[216:219]
    v_mfma_f32_16x16x32_bf16 v[220:223], v[100:103], v[0:3], v[220:223]
    ds_read_b128 v[236:239], v252 offset:45056
    v_fmac_f32 v21, v13, v25
    v_fmac_f32 v22, v14, v25
    v_fmac_f32 v23, v15, v25
    v_fmac_f32 v16, v180, v24
    v_fmac_f32 v17, v181, v24
    v_fmac_f32 v18, v182, v24
    v_mfma_f32_16x16x32_bf16 v[224:227], v[96:99], v[4:7], v[224:227]
    v_mfma_f32_16x16x32_bf16 v[228:231], v[100:103], v[4:7], v[228:231]
    s_add_u32 s17, s12, 4096
    buffer_load_dwordx4 v[96:99], v252, s[68:71], s17 offen offset:0 sc1
    s_add_u32 s17, s12, 20480
    buffer_load_dwordx4 v[100:103], v252, s[68:71], s17 offen offset:0 sc1
    ds_read_b128 v[0:3], v252 offset:49152
    v_fmac_f32 v19, v183, v24
    v_fmac_f32 v20, v188, v24
    v_fmac_f32 v21, v189, v24
    v_fmac_f32 v22, v190, v24
    v_fmac_f32 v23, v191, v24
    v_mul_f32 v8, v16, v16
    v_mfma_f32_16x16x32_bf16 v[192:195], v[104:107], v[32:35], v[192:195]
    v_mfma_f32_16x16x32_bf16 v[196:199], v[108:111], v[32:35], v[196:199]
    ds_read_b128 v[4:7], v252 offset:50176
    v_mul_f32 v9, v17, v17
    v_mul_f32 v10, v18, v18
    v_mul_f32 v11, v19, v19
    v_mul_f32 v12, v20, v20
    v_mul_f32 v13, v21, v21
    v_mul_f32 v14, v22, v22
    v_mfma_f32_16x16x32_bf16 v[200:203], v[104:107], v[36:39], v[200:203]
    v_mfma_f32_16x16x32_bf16 v[204:207], v[108:111], v[36:39], v[204:207]
    ds_read_b128 v[32:35], v252 offset:51200
    v_mul_f32 v15, v23, v23
    v_fma_f32 v8, v8, s8, v248
    v_fma_f32 v9, v9, s8, v248
    v_fma_f32 v10, v10, s8, v248
    v_fma_f32 v11, v11, s8, v248
    v_fma_f32 v12, v12, s8, v248
    v_mfma_f32_16x16x32_bf16 v[208:211], v[104:107], v[240:243], v[208:211]
    v_mfma_f32_16x16x32_bf16 v[212:215], v[108:111], v[240:243], v[212:215]
    ds_read_b128 v[36:39], v252 offset:52224
    v_fma_f32 v13, v13, s8, v248
    v_fma_f32 v14, v14, s8, v248
    v_fma_f32 v15, v15, s8, v248
    v_mul_f32 v8, v8, v16
    v_mul_f32 v9, v9, v17
    v_mul_f32 v10, v10, v18
    s_waitcnt lgkmcnt(5)
    v_mfma_f32_16x16x32_bf16 v[216:219], v[104:107], v[232:235], v[216:219]
    v_mfma_f32_16x16x32_bf16 v[220:223], v[108:111], v[232:235], v[220:223]
    ds_read_b128 v[240:243], v252 offset:53248
    v_mul_f32 v11, v11, v19
    v_mul_f32 v12, v12, v20
    v_mul_f32 v13, v13, v21
    v_mul_f32 v14, v14, v22
    v_mul_f32 v15, v15, v23
    v_exp_f32 v8, v8
    s_waitcnt lgkmcnt(5)
    v_mfma_f32_16x16x32_bf16 v[224:227], v[104:107], v[236:239], v[224:227]
    v_mfma_f32_16x16x32_bf16 v[228:231], v[108:111], v[236:239], v[228:231]
    buffer_load_dwordx4 v[104:107], v252, s[68:71], s17 offen offset:1024 sc1
    buffer_load_dwordx4 v[108:111], v252, s[68:71], s17 offen offset:2048 sc1
    ds_read_b128 v[232:235], v252 offset:57344
    v_exp_f32 v9, v9
    v_exp_f32 v10, v10
    v_exp_f32 v11, v11
    v_exp_f32 v12, v12
    v_exp_f32 v13, v13
    v_exp_f32 v14, v14
    s_waitcnt lgkmcnt(5)
    v_mfma_f32_16x16x32_bf16 v[192:195], v[112:115], v[0:3], v[192:195]
    v_mfma_f32_16x16x32_bf16 v[196:199], v[116:119], v[0:3], v[196:199]
    ds_read_b128 v[236:239], v252 offset:58368
    v_exp_f32 v15, v15
    v_fma_f32 v8, v8, v27, v27
    v_fma_f32 v9, v9, v27, v27
    v_fma_f32 v10, v10, v27, v27
    v_fma_f32 v11, v11, v27, v27
    v_fma_f32 v12, v12, v27, v27
    s_waitcnt lgkmcnt(5)
    v_mfma_f32_16x16x32_bf16 v[200:203], v[112:115], v[4:7], v[200:203]
    v_mfma_f32_16x16x32_bf16 v[204:207], v[116:119], v[4:7], v[204:207]
    ds_read_b128 v[0:3], v252 offset:59392
    v_fma_f32 v13, v13, v27, v27
    v_fma_f32 v14, v14, v27, v27
    v_fma_f32 v15, v15, v27, v27
    v_rcp_f32 v8, v8
    v_rcp_f32 v9, v9
    v_rcp_f32 v10, v10
    s_waitcnt lgkmcnt(5)
    v_mfma_f32_16x16x32_bf16 v[208:211], v[112:115], v[32:35], v[208:211]
    v_mfma_f32_16x16x32_bf16 v[212:215], v[116:119], v[32:35], v[212:215]
    ds_read_b128 v[4:7], v252 offset:60416
    v_rcp_f32 v11, v11
    v_rcp_f32 v12, v12
    v_rcp_f32 v13, v13
    v_rcp_f32 v14, v14
    v_rcp_f32 v15, v15
    v_mul_f32 v16, v16, v8
    s_waitcnt lgkmcnt(5)
    v_mfma_f32_16x16x32_bf16 v[216:219], v[112:115], v[36:39], v[216:219]
    v_mfma_f32_16x16x32_bf16 v[220:223], v[116:119], v[36:39], v[220:223]
    ds_read_b128 v[32:35], v252 offset:61440
    v_mul_f32 v17, v17, v9
    v_mul_f32 v18, v18, v10
    v_mul_f32 v19, v19, v11
    v_mul_f32 v20, v20, v12
    v_mul_f32 v21, v21, v13
    v_mul_f32 v22, v22, v14
    s_waitcnt lgkmcnt(5)
    v_mfma_f32_16x16x32_bf16 v[224:227], v[112:115], v[240:243], v[224:227]
    v_mfma_f32_16x16x32_bf16 v[228:231], v[116:119], v[240:243], v[228:231]
    buffer_load_dwordx4 v[112:115], v252, s[68:71], s17 offen offset:3072 sc1
    s_add_u32 s17, s12, 24576
    buffer_load_dwordx4 v[116:119], v252, s[68:71], s17 offen offset:0 sc1
    ds_read_b128 v[36:39], v246 offset:0
    v_mul_f32 v23, v23, v15
    v_cvt_pk_bf16_f32 v180, v16, v17
    v_cvt_pk_bf16_f32 v181, v18, v19
    v_cvt_pk_bf16_f32 v182, v20, v21
    v_cvt_pk_bf16_f32 v183, v22, v23
    s_add_u32 s5, s10, 75776
    buffer_store_dwordx4 v[180:183], v247, s[68:71], s5 offen offset:1024 sc1
    s_waitcnt lgkmcnt(5)
    v_mfma_f32_16x16x32_bf16 v[192:195], v[120:123], v[232:235], v[192:195]
    v_mfma_f32_16x16x32_bf16 v[196:199], v[124:127], v[232:235], v[196:199]
    ds_read_b128 v[240:243], v246 offset:1024
    s_waitcnt lgkmcnt(5)
    v_mfma_f32_16x16x32_bf16 v[200:203], v[120:123], v[236:239], v[200:203]
    v_mfma_f32_16x16x32_bf16 v[204:207], v[124:127], v[236:239], v[204:207]
    ds_read_b128 v[232:235], v246 offset:2048
    s_waitcnt lgkmcnt(5)
    v_mfma_f32_16x16x32_bf16 v[208:211], v[120:123], v[0:3], v[208:211]
    v_mfma_f32_16x16x32_bf16 v[212:215], v[124:127], v[0:3], v[212:215]
    ds_read_b128 v[236:239], v246 offset:3072
    s_waitcnt lgkmcnt(5)
    v_mfma_f32_16x16x32_bf16 v[216:219], v[120:123], v[4:7], v[216:219]
    v_mfma_f32_16x16x32_bf16 v[220:223], v[124:127], v[4:7], v[220:223]
    ds_read_b128 v[0:3], v246 offset:4096
    s_waitcnt lgkmcnt(5)
    v_mfma_f32_16x16x32_bf16 v[224:227], v[120:123], v[32:35], v[224:227]
    v_mfma_f32_16x16x32_bf16 v[228:231], v[124:127], v[32:35], v[228:231]
    s_add_u32 s17, s12, 40960
    buffer_load_dwordx4 v[120:123], v252, s[68:71], s17 offen offset:0 sc1
    buffer_load_dwordx4 v[124:127], v252, s[68:71], s17 offen offset:1024 sc1
    s_waitcnt vmcnt(2)
    s_barrier
    ds_read_b128 v[4:7], v246 offset:8192
    s_waitcnt lgkmcnt(5)
    v_mfma_f32_16x16x32_bf16 v[192:195], v[128:131], v[36:39], v[192:195]
    v_mfma_f32_16x16x32_bf16 v[196:199], v[132:135], v[36:39], v[196:199]
    ds_read_b128 v[32:35], v246 offset:9216
    s_waitcnt lgkmcnt(5)
    v_mfma_f32_16x16x32_bf16 v[200:203], v[128:131], v[240:243], v[200:203]
    v_mfma_f32_16x16x32_bf16 v[204:207], v[132:135], v[240:243], v[204:207]
    ds_read_b128 v[36:39], v246 offset:10240
    s_waitcnt lgkmcnt(5)
    v_mfma_f32_16x16x32_bf16 v[208:211], v[128:131], v[232:235], v[208:211]
    v_mfma_f32_16x16x32_bf16 v[212:215], v[132:135], v[232:235], v[212:215]
    ds_read_b128 v[240:243], v246 offset:11264
    s_waitcnt lgkmcnt(5)
    v_mfma_f32_16x16x32_bf16 v[216:219], v[128:131], v[236:239], v[216:219]
    v_mfma_f32_16x16x32_bf16 v[220:223], v[132:135], v[236:239], v[220:223]
    ds_read_b128 v[232:235], v246 offset:12288
    s_waitcnt lgkmcnt(5)
    v_mfma_f32_16x16x32_bf16 v[224:227], v[128:131], v[0:3], v[224:227]
    v_mfma_f32_16x16x32_bf16 v[228:231], v[132:135], v[0:3], v[228:231]
    buffer_load_dwordx4 v[128:131], v252, s[68:71], s17 offen offset:2048 sc1
    buffer_load_dwordx4 v[132:135], v252, s[68:71], s17 offen offset:3072 sc1
    ds_read_b128 v[236:239], v246 offset:16384
    s_waitcnt lgkmcnt(5)
    v_mfma_f32_16x16x32_bf16 v[192:195], v[136:139], v[4:7], v[192:195]
    v_mfma_f32_16x16x32_bf16 v[196:199], v[140:143], v[4:7], v[196:199]
    ds_read_b128 v[0:3], v246 offset:17408
    s_waitcnt lgkmcnt(5)
    v_mfma_f32_16x16x32_bf16 v[200:203], v[136:139], v[32:35], v[200:203]
    v_mfma_f32_16x16x32_bf16 v[204:207], v[140:143], v[32:35], v[204:207]
    ds_read_b128 v[4:7], v246 offset:18432
    s_waitcnt lgkmcnt(5)
    v_mfma_f32_16x16x32_bf16 v[208:211], v[136:139], v[36:39], v[208:211]
    v_mfma_f32_16x16x32_bf16 v[212:215], v[140:143], v[36:39], v[212:215]
    ds_read_b128 v[32:35], v246 offset:19456
    s_waitcnt lgkmcnt(5)
    v_mfma_f32_16x16x32_bf16 v[216:219], v[136:139], v[240:243], v[216:219]
    v_mfma_f32_16x16x32_bf16 v[220:223], v[140:143], v[240:243], v[220:223]
    ds_read_b128 v[36:39], v246 offset:20480
    s_waitcnt lgkmcnt(5)
    v_mfma_f32_16x16x32_bf16 v[224:227], v[136:139], v[232:235], v[224:227]
    v_mfma_f32_16x16x32_bf16 v[228:231], v[140:143], v[232:235], v[228:231]
    s_add_u32 s17, s12, 45056
    buffer_load_dwordx4 v[136:139], v252, s[68:71], s17 offen offset:0 sc1
    s_add_u32 s17, s12, 61440
    buffer_load_dwordx4 v[140:143], v252, s[68:71], s17 offen offset:0 sc1
    ds_read_b128 v[240:243], v246 offset:24576
    s_waitcnt lgkmcnt(5)
    v_mfma_f32_16x16x32_bf16 v[192:195], v[144:147], v[236:239], v[192:195]
    v_mfma_f32_16x16x32_bf16 v[196:199], v[148:151], v[236:239], v[196:199]
    ds_read_b128 v[232:235], v246 offset:25600
    s_waitcnt lgkmcnt(5)
    v_mfma_f32_16x16x32_bf16 v[200:203], v[144:147], v[0:3], v[200:203]
    v_mfma_f32_16x16x32_bf16 v[204:207], v[148:151], v[0:3], v[204:207]
    ds_read_b128 v[236:239], v246 offset:26624
    s_waitcnt lgkmcnt(5)
    v_mfma_f32_16x16x32_bf16 v[208:211], v[144:147], v[4:7], v[208:211]
    v_mfma_f32_16x16x32_bf16 v[212:215], v[148:151], v[4:7], v[212:215]
    ds_read_b128 v[0:3], v246 offset:27648
    s_waitcnt lgkmcnt(5)
    v_mfma_f32_16x16x32_bf16 v[216:219], v[144:147], v[32:35], v[216:219]
    v_mfma_f32_16x16x32_bf16 v[220:223], v[148:151], v[32:35], v[220:223]
    ds_read_b128 v[4:7], v246 offset:28672
    s_waitcnt lgkmcnt(5)
    v_mfma_f32_16x16x32_bf16 v[224:227], v[144:147], v[36:39], v[224:227]
    v_mfma_f32_16x16x32_bf16 v[228:231], v[148:151], v[36:39], v[228:231]
    buffer_load_dwordx4 v[144:147], v252, s[68:71], s17 offen offset:1024 sc1
    buffer_load_dwordx4 v[148:151], v252, s[68:71], s17 offen offset:2048 sc1
    s_waitcnt lgkmcnt(4)
    v_mfma_f32_16x16x32_bf16 v[192:195], v[152:155], v[240:243], v[192:195]
    v_mfma_f32_16x16x32_bf16 v[196:199], v[156:159], v[240:243], v[196:199]
    s_waitcnt lgkmcnt(3)
    v_mfma_f32_16x16x32_bf16 v[200:203], v[152:155], v[232:235], v[200:203]
    v_mfma_f32_16x16x32_bf16 v[204:207], v[156:159], v[232:235], v[204:207]
    s_waitcnt lgkmcnt(2)
    v_mfma_f32_16x16x32_bf16 v[208:211], v[152:155], v[236:239], v[208:211]
    v_mfma_f32_16x16x32_bf16 v[212:215], v[156:159], v[236:239], v[212:215]
    s_waitcnt lgkmcnt(1)
    v_mfma_f32_16x16x32_bf16 v[216:219], v[152:155], v[0:3], v[216:219]
    v_mfma_f32_16x16x32_bf16 v[220:223], v[156:159], v[0:3], v[220:223]
    s_waitcnt lgkmcnt(0)
    v_mfma_f32_16x16x32_bf16 v[224:227], v[152:155], v[4:7], v[224:227]
    v_mfma_f32_16x16x32_bf16 v[228:231], v[156:159], v[4:7], v[228:231]
    buffer_load_dwordx4 v[152:155], v252, s[68:71], s17 offen offset:3072 sc1
    s_add_u32 s17, s12, 65536
    buffer_load_dwordx4 v[156:159], v252, s[68:71], s17 offen offset:0 sc1
    s_mov_b32 s8, 0x3fb8aa3b
    s_mov_b32 s9, s8
    s_mov_b32 s6, 0x358637bd
    s_mov_b32 s7, s6
    v_cmp_gt_u32 vcc, 8, v254
    v_mov_b32 v24, 0x3f803f80
    v_cvt_pk_bf16_f32 v8, v208, v209
    v_cvt_pk_bf16_f32 v12, v216, v217
    v_cvt_pk_bf16_f32 v20, v224, v225
    v_cvt_pk_bf16_f32 v9, v210, v211
    v_cvt_pk_bf16_f32 v13, v218, v219
    v_cvt_pk_bf16_f32 v21, v226, v227
    v_cvt_pk_bf16_f32 v10, v212, v213
    v_cvt_pk_bf16_f32 v14, v220, v221
    v_cvt_pk_bf16_f32 v22, v228, v229
    v_cvt_pk_bf16_f32 v11, v214, v215
    v_cvt_pk_bf16_f32 v15, v222, v223
    v_cvt_pk_bf16_f32 v23, v230, v231
    v_cndmask_b32 v20, v20, v24, vcc
    v_cndmask_b32 v21, v21, v24, vcc
    v_cndmask_b32 v22, v22, v24, vcc
    v_cndmask_b32 v23, v23, v24, vcc
    v_pk_mul_f32 v[24:25], v[192:193], s[8:9]
    v_pk_mul_f32 v[26:27], v[194:195], s[8:9]
    v_pk_mul_f32 v[28:29], v[196:197], s[8:9]
    v_pk_mul_f32 v[30:31], v[198:199], s[8:9]
    v_pk_mul_f32 v[32:33], v[200:201], s[8:9]
    v_pk_mul_f32 v[34:35], v[202:203], s[8:9]
    v_pk_mul_f32 v[36:37], v[204:205], s[8:9]
    v_pk_mul_f32 v[38:39], v[206:207], s[8:9]
    v_pk_mul_f32 v[40:41], v[224:225], s[8:9]
    v_pk_mul_f32 v[42:43], v[226:227], s[8:9]
    v_pk_mul_f32 v[44:45], v[228:229], s[8:9]
    v_pk_mul_f32 v[46:47], v[230:231], s[8:9]
    v_min_f32 v24, 0, v24
    v_min_f32 v25, 0, v25
    v_max_f32 v192, 0, v192
    v_max_f32 v193, 0, v193
    v_min_f32 v26, 0, v26
    v_min_f32 v27, 0, v27
    v_max_f32 v194, 0, v194
    v_max_f32 v195, 0, v195
    v_min_f32 v28, 0, v28
    v_min_f32 v29, 0, v29
    v_max_f32 v196, 0, v196
    v_max_f32 v197, 0, v197
    v_min_f32 v30, 0, v30
    v_min_f32 v31, 0, v31
    v_max_f32 v198, 0, v198
    v_max_f32 v199, 0, v199
    v_min_f32 v32, 0, v32
    v_min_f32 v33, 0, v33
    v_max_f32 v200, 0, v200
    v_max_f32 v201, 0, v201
    v_min_f32 v34, 0, v34
    v_min_f32 v35, 0, v35
    v_max_f32 v202, 0, v202
    v_max_f32 v203, 0, v203
    v_min_f32 v36, 0, v36
    v_min_f32 v37, 0, v37
    v_max_f32 v204, 0, v204
    v_max_f32 v205, 0, v205
    v_min_f32 v38, 0, v38
    v_min_f32 v39, 0, v39
    v_max_f32 v206, 0, v206
    v_max_f32 v207, 0, v207
    v_min_f32 v40, 0, v40
    v_min_f32 v41, 0, v41
    v_max_f32 v224, 0, v224
    v_max_f32 v225, 0, v225
    v_min_f32 v42, 0, v42
    v_min_f32 v43, 0, v43
    v_max_f32 v226, 0, v226
    v_max_f32 v227, 0, v227
    v_min_f32 v44, 0, v44
    v_min_f32 v45, 0, v45
    v_max_f32 v228, 0, v228
    v_max_f32 v229, 0, v229
    v_min_f32 v46, 0, v46
    v_min_f32 v47, 0, v47
    v_max_f32 v230, 0, v230
    v_max_f32 v231, 0, v231
    v_exp_f32 v24, v24
    v_exp_f32 v25, v25
    v_pk_add_f32 v[192:193], v[192:193], s[6:7]
    v_exp_f32 v26, v26
    v_exp_f32 v27, v27
    v_pk_add_f32 v[194:195], v[194:195], s[6:7]
    v_exp_f32 v28, v28
    v_exp_f32 v29, v29
    v_pk_add_f32 v[196:197], v[196:197], s[6:7]
    v_exp_f32 v30, v30
    v_exp_f32 v31, v31
    v_pk_add_f32 v[198:199], v[198:199], s[6:7]
    v_exp_f32 v32, v32
    v_exp_f32 v33, v33
    v_pk_add_f32 v[200:201], v[200:201], s[6:7]
    v_exp_f32 v34, v34
    v_exp_f32 v35, v35
    v_pk_add_f32 v[202:203], v[202:203], s[6:7]
    v_exp_f32 v36, v36
    v_exp_f32 v37, v37
    v_pk_add_f32 v[204:205], v[204:205], s[6:7]
    v_exp_f32 v38, v38
    v_exp_f32 v39, v39
    v_pk_add_f32 v[206:207], v[206:207], s[6:7]
    v_exp_f32 v40, v40
    v_exp_f32 v41, v41
    v_pk_add_f32 v[224:225], v[224:225], s[6:7]
    v_exp_f32 v42, v42
    v_exp_f32 v43, v43
    v_pk_add_f32 v[226:227], v[226:227], s[6:7]
    v_exp_f32 v44, v44
    v_exp_f32 v45, v45
    v_pk_add_f32 v[228:229], v[228:229], s[6:7]
    v_exp_f32 v46, v46
    v_exp_f32 v47, v47
    v_pk_add_f32 v[230:231], v[230:231], s[6:7]
    v_pk_add_f32 v[192:193], v[192:193], v[24:25]
    v_pk_add_f32 v[194:195], v[194:195], v[26:27]
    v_pk_add_f32 v[196:197], v[196:197], v[28:29]
    v_pk_add_f32 v[198:199], v[198:199], v[30:31]
    v_pk_add_f32 v[200:201], v[200:201], v[32:33]
    v_pk_add_f32 v[202:203], v[202:203], v[34:35]
    v_pk_add_f32 v[204:205], v[204:205], v[36:37]
    v_pk_add_f32 v[206:207], v[206:207], v[38:39]
    v_pk_add_f32 v[224:225], v[224:225], v[40:41]
    v_pk_add_f32 v[226:227], v[226:227], v[42:43]
    v_pk_add_f32 v[228:229], v[228:229], v[44:45]
    v_pk_add_f32 v[230:231], v[230:231], v[46:47]
    v_cvt_pk_bf16_f32 v0, v192, v193
    v_cvt_pk_bf16_f32 v1, v194, v195
    v_cvt_pk_bf16_f32 v2, v196, v197
    v_cvt_pk_bf16_f32 v3, v198, v199
    v_cvt_pk_bf16_f32 v4, v200, v201
    v_cvt_pk_bf16_f32 v5, v202, v203
    v_cvt_pk_bf16_f32 v6, v204, v205
    v_cvt_pk_bf16_f32 v7, v206, v207
    v_cvt_pk_bf16_f32 v16, v224, v225
    v_cvt_pk_bf16_f32 v17, v226, v227
    v_cvt_pk_bf16_f32 v18, v228, v229
    v_cvt_pk_bf16_f32 v19, v230, v231
    v_mfma_f32_16x16x32_bf16 v[24:27], v[0:3], v[8:11], 0
    v_mfma_f32_16x16x32_bf16 v[28:31], v[4:7], v[12:15], 0
    v_mfma_f32_16x16x32_bf16 v[32:35], v[0:3], v[20:23], 0
    v_mfma_f32_16x16x32_bf16 v[36:39], v[4:7], v[20:23], 0
    v_mfma_f32_16x16x32_bf16 v[40:43], v[16:19], v[8:11], 0
    v_mfma_f32_16x16x32_bf16 v[44:47], v[16:19], v[12:15], 0
    v_mfma_f32_16x16x32_bf16 v[48:51], v[16:19], v[20:23], 0
    s_cmp_lg_u32 s79, 0
    s_cbranch_scc1 L_nH
    buffer_load_dword v249, v251, s[68:71], s14 offen sc1
L_nH:
    v_mul_u32_u24 v52, 80, v254
    s_lshl_b32 s4, s79, 13
    v_add_u32 v52, s4, v52
    v_lshlrev_b32 v53, 4, v253
    s_add_u32 s5, s4, 4096
    v_add_u32 v54, s5, v252
    v_lshrrev_b32 v55, 2, v254
    v_add_u32 v56, 640, v52
    v_cmp_eq_u32 vcc, 2, v55
    s_nop 1
    v_cndmask_b32 v56, v54, v56, vcc
    v_add_u32 v57, 2000, v52
    v_cmp_eq_u32 vcc, 3, v55
    s_nop 1
    v_cndmask_b32 v57, v54, v57, vcc
    v_add_u32 v58, 1600, v52
    v_add_u32 v59, 3280, v52
    v_cmp_eq_u32 vcc, 0, v254
    s_nop 1
    v_cndmask_b32 v56, v56, v58, vcc
    v_cndmask_b32 v57, v57, v59, vcc
    v_add_u32 v60, v52, v53
    v_add_u32 v62, v56, v53
    v_add_u32 v63, v57, v53
    v_cmp_eq_u32 vcc, 0, v253
    s_nop 1
    v_cndmask_b32 v64, v54, v52, vcc
    v_cndmask_b32 v66, v54, v56, vcc
    v_add_u32 v52, 1680, v52
    v_cmp_eq_u32 vcc, 1, v253
    s_nop 1
    v_cndmask_b32 v65, v54, v52, vcc
    v_cndmask_b32 v66, v66, v57, vcc
    ds_write_b128 v60, v[24:27] offset:0
    ds_write_b128 v60, v[28:31] offset:1680
    ds_write_b128 v62, v[32:35] offset:0
    ds_write_b128 v63, v[36:39] offset:0
    ds_write_b128 v64, v[40:43] offset:64
    ds_write_b128 v65, v[44:47] offset:64
    ds_write_b128 v66, v[48:51] offset:64
    s_waitcnt lgkmcnt(0)
    s_barrier
    s_cmp_lg_u32 s79, 0
    s_cbranch_scc1 L_nH2
    s_waitcnt vmcnt(0)
    s_mov_b32 s5, 20000
L_sp2:
    v_cmp_gt_u32 vcc, 16, v249
    s_nop 4
    s_cbranch_vccz L_ok2
    s_sub_u32 s5, s5, 1
    s_cbranch_scc1 L_ok2
    s_sleep 4
    buffer_load_dword v249, v251, s[68:71], s14 offen sc1
    s_waitcnt vmcnt(0)
    s_branch L_sp2
L_ok2:
L_nH3:
    v_mov_b32 v244, 145416
    v_mov_b32 v245, 1
    ds_write_b32 v244, v245
L_nH2:
    v_mov_b32 v244, 145416
    s_mov_b32 s5, 320000
L_sp3:
    ds_read_b32 v245, v244
    s_waitcnt lgkmcnt(0)
    v_cmp_gt_u32 vcc, 1, v245
    s_nop 4
    s_cbranch_vccz L_ok3
    s_sub_u32 s5, s5, 1
    s_cbranch_scc1 L_ok3
    s_sleep 1
    s_branch L_sp3
L_ok3:
    s_add_u32 s4, s13, 0
    buffer_load_dwordx4 v[160:163], v252, s[68:71], s4 offen sc1
    s_add_u32 s4, s13, 75776
    buffer_load_dwordx4 v[164:167], v252, s[68:71], s4 offen sc1
    s_add_u32 s4, s13, 151552
    buffer_load_dwordx4 v[168:171], v252, s[68:71], s4 offen sc1
    s_add_u32 s4, s13, 227328
    buffer_load_dwordx4 v[172:175], v252, s[68:71], s4 offen sc1
    s_add_u32 s4, s13, 4096
    buffer_load_dwordx4 v[176:179], v252, s[68:71], s4 offen sc1
    s_add_u32 s4, s13, 79872
    buffer_load_dwordx4 v[180:183], v252, s[68:71], s4 offen sc1
    s_add_u32 s4, s13, 155648
    buffer_load_dwordx4 v[184:187], v252, s[68:71], s4 offen sc1
    s_add_u32 s4, s13, 231424
    buffer_load_dwordx4 v[188:191], v252, s[68:71], s4 offen sc1
L_eH:
    s_add_u32 s4, s13, 8192
    buffer_load_dwordx4 v[192:195], v252, s[68:71], s4 offen sc1
    s_add_u32 s4, s13, 83968
    buffer_load_dwordx4 v[196:199], v252, s[68:71], s4 offen sc1
    s_add_u32 s4, s13, 159744
    buffer_load_dwordx4 v[200:203], v252, s[68:71], s4 offen sc1
    s_add_u32 s4, s13, 235520
    buffer_load_dwordx4 v[204:207], v252, s[68:71], s4 offen sc1
    s_waitcnt vmcnt(11)
    v_mfma_f32_16x16x32_bf16 v[0:3], v[80:83], v[160:163], 0
    s_add_u32 s4, s13, 12288
    buffer_load_dwordx4 v[208:211], v252, s[68:71], s4 offen sc1
    v_mfma_f32_16x16x32_bf16 v[4:7], v[84:87], v[160:163], 0
    v_mfma_f32_16x16x32_bf16 v[8:11], v[88:91], v[160:163], 0
    s_add_u32 s4, s13, 88064
    buffer_load_dwordx4 v[212:215], v252, s[68:71], s4 offen sc1
    v_mfma_f32_16x16x32_bf16 v[12:15], v[92:95], v[160:163], 0
    v_mfma_f32_16x16x32_bf16 v[16:19], v[96:99], v[160:163], 0
    s_add_u32 s4, s13, 163840
    buffer_load_dwordx4 v[216:219], v252, s[68:71], s4 offen sc1
    s_waitcnt vmcnt(13)
    v_mfma_f32_16x16x32_bf16 v[20:23], v[80:83], v[164:167], 0
    v_mfma_f32_16x16x32_bf16 v[24:27], v[84:87], v[164:167], 0
    s_add_u32 s4, s13, 239616
    buffer_load_dwordx4 v[220:223], v252, s[68:71], s4 offen sc1
    v_mfma_f32_16x16x32_bf16 v[28:31], v[88:91], v[164:167], 0
    v_mfma_f32_16x16x32_bf16 v[32:35], v[92:95], v[164:167], 0
    v_mfma_f32_16x16x32_bf16 v[36:39], v[96:99], v[164:167], 0
    s_waitcnt vmcnt(13)
    v_mfma_f32_16x16x32_bf16 v[40:43], v[80:83], v[168:171], 0
    v_mfma_f32_16x16x32_bf16 v[44:47], v[84:87], v[168:171], 0
    v_mfma_f32_16x16x32_bf16 v[48:51], v[88:91], v[168:171], 0
    v_mfma_f32_16x16x32_bf16 v[52:55], v[92:95], v[168:171], 0
    v_mfma_f32_16x16x32_bf16 v[56:59], v[96:99], v[168:171], 0
    s_waitcnt vmcnt(12)
    v_mfma_f32_16x16x32_bf16 v[60:63], v[80:83], v[172:175], 0
    v_mfma_f32_16x16x32_bf16 v[64:67], v[84:87], v[172:175], 0
    v_mfma_f32_16x16x32_bf16 v[68:71], v[88:91], v[172:175], 0
    v_mfma_f32_16x16x32_bf16 v[72:75], v[92:95], v[172:175], 0
    v_mfma_f32_16x16x32_bf16 v[76:79], v[96:99], v[172:175], 0
    s_add_u32 s20, s79, 2
    s_and_b32 s21, s79, 2
    s_add_u32 s20, s20, s21
    s_lshl_b32 s20, s20, 14
    s_lshl_b32 s21, s79, 13
    s_add_u32 s21, s21, 65536
    s_lshl_b32 s22, s79, 2
    s_add_u32 s22, s22, 145440
    v_add_u32 v246, s20, v252
    v_add_u32 v247, s21, v252
    v_mov_b32 v244, s22
    s_mov_b32 s5, 320000
L_sp4:
    ds_read_b32 v245, v244
    s_waitcnt lgkmcnt(0)
    v_cmp_gt_u32 vcc, 1, v245
    s_nop 4
    s_cbranch_vccz L_ok4
    s_sub_u32 s5, s5, 1
    s_cbranch_scc1 L_ok4
    s_sleep 1
    s_branch L_sp4
L_ok4:
    s_waitcnt vmcnt(11)
    v_mfma_f32_16x16x32_bf16 v[0:3], v[100:103], v[176:179], v[0:3]
    s_add_u32 s4, s13, 16384
    buffer_load_dwordx4 v[160:163], v252, s[68:71], s4 offen sc1
    v_mfma_f32_16x16x32_bf16 v[4:7], v[104:107], v[176:179], v[4:7]
    v_mfma_f32_16x16x32_bf16 v[8:11], v[108:111], v[176:179], v[8:11]
    s_add_u32 s4, s13, 92160
    buffer_load_dwordx4 v[164:167], v252, s[68:71], s4 offen sc1
    v_mfma_f32_16x16x32_bf16 v[12:15], v[112:115], v[176:179], v[12:15]
    v_mfma_f32_16x16x32_bf16 v[16:19], v[116:119], v[176:179], v[16:19]
    s_add_u32 s4, s13, 167936
    buffer_load_dwordx4 v[168:171], v252, s[68:71], s4 offen sc1
    s_waitcnt vmcnt(13)
    v_mfma_f32_16x16x32_bf16 v[20:23], v[100:103], v[180:183], v[20:23]
    v_mfma_f32_16x16x32_bf16 v[24:27], v[104:107], v[180:183], v[24:27]
    s_add_u32 s4, s13, 243712
    buffer_load_dwordx4 v[172:175], v252, s[68:71], s4 offen sc1
    v_mfma_f32_16x16x32_bf16 v[28:31], v[108:111], v[180:183], v[28:31]
    v_mfma_f32_16x16x32_bf16 v[32:35], v[112:115], v[180:183], v[32:35]
    ds_read_b128 v[80:83], v246 offset:0
    v_mfma_f32_16x16x32_bf16 v[36:39], v[116:119], v[180:183], v[36:39]
    s_waitcnt vmcnt(13)
    v_mfma_f32_16x16x32_bf16 v[40:43], v[100:103], v[184:187], v[40:43]
    ds_read_b128 v[84:87], v246 offset:1024
    v_mfma_f32_16x16x32_bf16 v[44:47], v[104:107], v[184:187], v[44:47]
    v_mfma_f32_16x16x32_bf16 v[48:51], v[108:111], v[184:187], v[48:51]
    ds_read_b128 v[88:91], v246 offset:2048
    v_mfma_f32_16x16x32_bf16 v[52:55], v[112:115], v[184:187], v[52:55]
    v_mfma_f32_16x16x32_bf16 v[56:59], v[116:119], v[184:187], v[56:59]
    ds_read_b128 v[92:95], v246 offset:3072
    s_waitcnt vmcnt(12)
    v_mfma_f32_16x16x32_bf16 v[60:63], v[100:103], v[188:191], v[60:63]
    v_mfma_f32_16x16x32_bf16 v[64:67], v[104:107], v[188:191], v[64:67]
    ds_read_b128 v[96:99], v246 offset:4096
    v_mfma_f32_16x16x32_bf16 v[68:71], v[108:111], v[188:191], v[68:71]
    v_mfma_f32_16x16x32_bf16 v[72:75], v[112:115], v[188:191], v[72:75]
    v_mfma_f32_16x16x32_bf16 v[76:79], v[116:119], v[188:191], v[76:79]
    v_mov_b32 v244, 145420
    v_mov_b32 v245, 1
    ds_write_b32 v244, v245
    s_waitcnt vmcnt(11)
    v_mfma_f32_16x16x32_bf16 v[0:3], v[120:123], v[192:195], v[0:3]
    s_add_u32 s4, s13, 20480
    buffer_load_dwordx4 v[176:179], v252, s[68:71], s4 offen sc1
    v_mfma_f32_16x16x32_bf16 v[4:7], v[124:127], v[192:195], v[4:7]
    v_mfma_f32_16x16x32_bf16 v[8:11], v[128:131], v[192:195], v[8:11]
    s_add_u32 s4, s13, 96256
    buffer_load_dwordx4 v[180:183], v252, s[68:71], s4 offen sc1
    v_mfma_f32_16x16x32_bf16 v[12:15], v[132:135], v[192:195], v[12:15]
    v_mfma_f32_16x16x32_bf16 v[16:19], v[136:139], v[192:195], v[16:19]
    s_add_u32 s4, s13, 172032
    buffer_load_dwordx4 v[184:187], v252, s[68:71], s4 offen sc1
    s_waitcnt vmcnt(13)
    v_mfma_f32_16x16x32_bf16 v[20:23], v[120:123], v[196:199], v[20:23]
    v_mfma_f32_16x16x32_bf16 v[24:27], v[124:127], v[196:199], v[24:27]
    s_add_u32 s4, s13, 247808
    buffer_load_dwordx4 v[188:191], v252, s[68:71], s4 offen sc1
    v_mfma_f32_16x16x32_bf16 v[28:31], v[128:131], v[196:199], v[28:31]
    v_mfma_f32_16x16x32_bf16 v[32:35], v[132:135], v[196:199], v[32:35]
    ds_read_b128 v[100:103], v246 offset:5120
    v_mfma_f32_16x16x32_bf16 v[36:39], v[136:139], v[196:199], v[36:39]
    s_waitcnt vmcnt(13)
    v_mfma_f32_16x16x32_bf16 v[40:43], v[120:123], v[200:203], v[40:43]
    ds_read_b128 v[104:107], v246 offset:6144
    v_mfma_f32_16x16x32_bf16 v[44:47], v[124:127], v[200:203], v[44:47]
    v_mfma_f32_16x16x32_bf16 v[48:51], v[128:131], v[200:203], v[48:51]
    ds_read_b128 v[108:111], v246 offset:7168
    v_mfma_f32_16x16x32_bf16 v[52:55], v[132:135], v[200:203], v[52:55]
    v_mfma_f32_16x16x32_bf16 v[56:59], v[136:139], v[200:203], v[56:59]
    ds_read_b128 v[112:115], v246 offset:8192
    s_waitcnt vmcnt(12)
    v_mfma_f32_16x16x32_bf16 v[60:63], v[120:123], v[204:207], v[60:63]
    v_mfma_f32_16x16x32_bf16 v[64:67], v[124:127], v[204:207], v[64:67]
    ds_read_b128 v[116:119], v246 offset:9216
    v_mfma_f32_16x16x32_bf16 v[68:71], v[128:131], v[204:207], v[68:71]
    v_mfma_f32_16x16x32_bf16 v[72:75], v[132:135], v[204:207], v[72:75]
    v_mfma_f32_16x16x32_bf16 v[76:79], v[136:139], v[204:207], v[76:79]
    s_waitcnt vmcnt(11)
    v_mfma_f32_16x16x32_bf16 v[0:3], v[140:143], v[208:211], v[0:3]
    s_add_u32 s4, s13, 24576
    buffer_load_dwordx4 v[192:195], v252, s[68:71], s4 offen sc1
    v_mfma_f32_16x16x32_bf16 v[4:7], v[144:147], v[208:211], v[4:7]
    v_mfma_f32_16x16x32_bf16 v[8:11], v[148:151], v[208:211], v[8:11]
    s_add_u32 s4, s13, 100352
    buffer_load_dwordx4 v[196:199], v252, s[68:71], s4 offen sc1
    v_mfma_f32_16x16x32_bf16 v[12:15], v[152:155], v[208:211], v[12:15]
    v_mfma_f32_16x16x32_bf16 v[16:19], v[156:159], v[208:211], v[16:19]
    s_add_u32 s4, s13, 176128
    buffer_load_dwordx4 v[200:203], v252, s[68:71], s4 offen sc1
    s_waitcnt vmcnt(13)
    v_mfma_f32_16x16x32_bf16 v[20:23], v[140:143], v[212:215], v[20:23]
    v_mfma_f32_16x16x32_bf16 v[24:27], v[144:147], v[212:215], v[24:27]
    s_add_u32 s4, s13, 251904
    buffer_load_dwordx4 v[204:207], v252, s[68:71], s4 offen sc1
    v_mfma_f32_16x16x32_bf16 v[28:31], v[148:151], v[212:215], v[28:31]
    v_mfma_f32_16x16x32_bf16 v[32:35], v[152:155], v[212:215], v[32:35]
    ds_read_b128 v[120:123], v246 offset:10240
    v_mfma_f32_16x16x32_bf16 v[36:39], v[156:159], v[212:215], v[36:39]
    s_waitcnt vmcnt(13)
    v_mfma_f32_16x16x32_bf16 v[40:43], v[140:143], v[216:219], v[40:43]
    ds_read_b128 v[124:127], v246 offset:11264
    v_mfma_f32_16x16x32_bf16 v[44:47], v[144:147], v[216:219], v[44:47]
    v_mfma_f32_16x16x32_bf16 v[48:51], v[148:151], v[216:219], v[48:51]
    ds_read_b128 v[128:131], v246 offset:12288
    v_mfma_f32_16x16x32_bf16 v[52:55], v[152:155], v[216:219], v[52:55]
    v_mfma_f32_16x16x32_bf16 v[56:59], v[156:159], v[216:219], v[56:59]
    ds_read_b128 v[132:135], v246 offset:13312
    s_waitcnt vmcnt(12)
    v_mfma_f32_16x16x32_bf16 v[60:63], v[140:143], v[220:223], v[60:63]
    v_mfma_f32_16x16x32_bf16 v[64:67], v[144:147], v[220:223], v[64:67]
    ds_read_b128 v[136:139], v246 offset:14336
    v_mfma_f32_16x16x32_bf16 v[68:71], v[148:151], v[220:223], v[68:71]
    v_mfma_f32_16x16x32_bf16 v[72:75], v[152:155], v[220:223], v[72:75]
    v_mfma_f32_16x16x32_bf16 v[76:79], v[156:159], v[220:223], v[76:79]
    s_waitcnt vmcnt(11)
    s_waitcnt lgkmcnt(11)
    v_mfma_f32_16x16x32_bf16 v[0:3], v[80:83], v[160:163], v[0:3]
    s_add_u32 s4, s13, 28672
    buffer_load_dwordx4 v[208:211], v252, s[68:71], s4 offen sc1
    v_mfma_f32_16x16x32_bf16 v[4:7], v[84:87], v[160:163], v[4:7]
    v_mfma_f32_16x16x32_bf16 v[8:11], v[88:91], v[160:163], v[8:11]
    s_add_u32 s4, s13, 104448
    buffer_load_dwordx4 v[212:215], v252, s[68:71], s4 offen sc1
    v_mfma_f32_16x16x32_bf16 v[12:15], v[92:95], v[160:163], v[12:15]
    v_mfma_f32_16x16x32_bf16 v[16:19], v[96:99], v[160:163], v[16:19]
    s_add_u32 s4, s13, 180224
    buffer_load_dwordx4 v[216:219], v252, s[68:71], s4 offen sc1
    s_waitcnt vmcnt(13)
    v_mfma_f32_16x16x32_bf16 v[20:23], v[80:83], v[164:167], v[20:23]
    v_mfma_f32_16x16x32_bf16 v[24:27], v[84:87], v[164:167], v[24:27]
    s_add_u32 s4, s13, 256000
    buffer_load_dwordx4 v[220:223], v252, s[68:71], s4 offen sc1
    v_mfma_f32_16x16x32_bf16 v[28:31], v[88:91], v[164:167], v[28:31]
    v_mfma_f32_16x16x32_bf16 v[32:35], v[92:95], v[164:167], v[32:35]
    s_add_u32 s17, s12, 143360
    buffer_load_dwordx4 v[140:143], v252, s[68:71], s17 offen offset:0 sc1
    v_mfma_f32_16x16x32_bf16 v[36:39], v[96:99], v[164:167], v[36:39]
    s_waitcnt vmcnt(14)
    v_mfma_f32_16x16x32_bf16 v[40:43], v[80:83], v[168:171], v[40:43]
    buffer_load_dwordx4 v[144:147], v252, s[68:71], s17 offen offset:1024 sc1
    v_mfma_f32_16x16x32_bf16 v[44:47], v[84:87], v[168:171], v[44:47]
    v_mfma_f32_16x16x32_bf16 v[48:51], v[88:91], v[168:171], v[48:51]
    buffer_load_dwordx4 v[148:151], v252, s[68:71], s17 offen offset:2048 sc1
    v_mfma_f32_16x16x32_bf16 v[52:55], v[92:95], v[168:171], v[52:55]
    v_mfma_f32_16x16x32_bf16 v[56:59], v[96:99], v[168:171], v[56:59]
    buffer_load_dwordx4 v[152:155], v252, s[68:71], s17 offen offset:3072 sc1
    s_waitcnt vmcnt(16)
    v_mfma_f32_16x16x32_bf16 v[60:63], v[80:83], v[172:175], v[60:63]
    v_mfma_f32_16x16x32_bf16 v[64:67], v[84:87], v[172:175], v[64:67]
    s_add_u32 s17, s12, 147456
    buffer_load_dwordx4 v[156:159], v252, s[68:71], s17 offen offset:0 sc1
    v_mfma_f32_16x16x32_bf16 v[68:71], v[88:91], v[172:175], v[68:71]
    v_mfma_f32_16x16x32_bf16 v[72:75], v[92:95], v[172:175], v[72:75]
    v_mfma_f32_16x16x32_bf16 v[76:79], v[96:99], v[172:175], v[76:79]
    s_waitcnt vmcnt(16)
    s_waitcnt lgkmcnt(5)
    v_mfma_f32_16x16x32_bf16 v[0:3], v[100:103], v[176:179], v[0:3]
    s_add_u32 s4, s13, 32768
    buffer_load_dwordx4 v[160:163], v252, s[68:71], s4 offen sc1
    v_mfma_f32_16x16x32_bf16 v[4:7], v[104:107], v[176:179], v[4:7]
    v_mfma_f32_16x16x32_bf16 v[8:11], v[108:111], v[176:179], v[8:11]
    s_add_u32 s4, s13, 108544
    buffer_load_dwordx4 v[164:167], v252, s[68:71], s4 offen sc1
    v_mfma_f32_16x16x32_bf16 v[12:15], v[112:115], v[176:179], v[12:15]
    v_mfma_f32_16x16x32_bf16 v[16:19], v[116:119], v[176:179], v[16:19]
    s_add_u32 s4, s13, 184320
    buffer_load_dwordx4 v[168:171], v252, s[68:71], s4 offen sc1
    s_waitcnt vmcnt(18)
    v_mfma_f32_16x16x32_bf16 v[20:23], v[100:103], v[180:183], v[20:23]
    v_mfma_f32_16x16x32_bf16 v[24:27], v[104:107], v[180:183], v[24:27]
    s_add_u32 s4, s13, 260096
    buffer_load_dwordx4 v[172:175], v252, s[68:71], s4 offen sc1
    v_mfma_f32_16x16x32_bf16 v[28:31], v[108:111], v[180:183], v[28:31]
    v_mfma_f32_16x16x32_bf16 v[32:35], v[112:115], v[180:183], v[32:35]
    s_add_u32 s17, s12, 163840
    buffer_load_dwordx4 v[80:83], v252, s[68:71], s17 offen offset:0 sc1
    v_mfma_f32_16x16x32_bf16 v[36:39], v[116:119], v[180:183], v[36:39]
    s_waitcnt vmcnt(19)
    v_mfma_f32_16x16x32_bf16 v[40:43], v[100:103], v[184:187], v[40:43]
    buffer_load_dwordx4 v[84:87], v252, s[68:71], s17 offen offset:1024 sc1
    v_mfma_f32_16x16x32_bf16 v[44:47], v[104:107], v[184:187], v[44:47]
    v_mfma_f32_16x16x32_bf16 v[48:51], v[108:111], v[184:187], v[48:51]
    buffer_load_dwordx4 v[88:91], v252, s[68:71], s17 offen offset:2048 sc1
    v_mfma_f32_16x16x32_bf16 v[52:55], v[112:115], v[184:187], v[52:55]
    v_mfma_f32_16x16x32_bf16 v[56:59], v[116:119], v[184:187], v[56:59]
    buffer_load_dwordx4 v[92:95], v252, s[68:71], s17 offen offset:3072 sc1
    s_waitcnt vmcnt(21)
    v_mfma_f32_16x16x32_bf16 v[60:63], v[100:103], v[188:191], v[60:63]
    v_mfma_f32_16x16x32_bf16 v[64:67], v[104:107], v[188:191], v[64:67]
    s_add_u32 s17, s12, 167936
    buffer_load_dwordx4 v[96:99], v252, s[68:71], s17 offen offset:0 sc1
    v_mfma_f32_16x16x32_bf16 v[68:71], v[108:111], v[188:191], v[68:71]
    v_mfma_f32_16x16x32_bf16 v[72:75], v[112:115], v[188:191], v[72:75]
    v_mfma_f32_16x16x32_bf16 v[76:79], v[116:119], v[188:191], v[76:79]
    s_waitcnt vmcnt(21)
    s_waitcnt lgkmcnt(0)
    v_mfma_f32_16x16x32_bf16 v[0:3], v[120:123], v[192:195], v[0:3]
    s_add_u32 s4, s13, 36864
    buffer_load_dwordx4 v[176:179], v252, s[68:71], s4 offen sc1
    v_mfma_f32_16x16x32_bf16 v[4:7], v[124:127], v[192:195], v[4:7]
    v_mfma_f32_16x16x32_bf16 v[8:11], v[128:131], v[192:195], v[8:11]
    s_add_u32 s4, s13, 112640
    buffer_load_dwordx4 v[180:183], v252, s[68:71], s4 offen sc1
    v_mfma_f32_16x16x32_bf16 v[12:15], v[132:135], v[192:195], v[12:15]
    v_mfma_f32_16x16x32_bf16 v[16:19], v[136:139], v[192:195], v[16:19]
    s_add_u32 s4, s13, 188416
    buffer_load_dwordx4 v[184:187], v252, s[68:71], s4 offen sc1
    s_waitcnt vmcnt(23)
    v_mfma_f32_16x16x32_bf16 v[20:23], v[120:123], v[196:199], v[20:23]
    v_mfma_f32_16x16x32_bf16 v[24:27], v[124:127], v[196:199], v[24:27]
    s_add_u32 s4, s13, 264192
    buffer_load_dwordx4 v[188:191], v252, s[68:71], s4 offen sc1
    v_mfma_f32_16x16x32_bf16 v[28:31], v[128:131], v[196:199], v[28:31]
    v_mfma_f32_16x16x32_bf16 v[32:35], v[132:135], v[196:199], v[32:35]
    s_add_u32 s17, s12, 184320
    buffer_load_dwordx4 v[100:103], v252, s[68:71], s17 offen offset:0 sc1
    v_mfma_f32_16x16x32_bf16 v[36:39], v[136:139], v[196:199], v[36:39]
    s_waitcnt vmcnt(24)
    v_mfma_f32_16x16x32_bf16 v[40:43], v[120:123], v[200:203], v[40:43]
    buffer_load_dwordx4 v[104:107], v252, s[68:71], s17 offen offset:1024 sc1
    v_mfma_f32_16x16x32_bf16 v[44:47], v[124:127], v[200:203], v[44:47]
    v_mfma_f32_16x16x32_bf16 v[48:51], v[128:131], v[200:203], v[48:51]
    buffer_load_dwordx4 v[108:111], v252, s[68:71], s17 offen offset:2048 sc1
    v_mfma_f32_16x16x32_bf16 v[52:55], v[132:135], v[200:203], v[52:55]
    v_mfma_f32_16x16x32_bf16 v[56:59], v[136:139], v[200:203], v[56:59]
    buffer_load_dwordx4 v[112:115], v252, s[68:71], s17 offen offset:3072 sc1
    s_waitcnt vmcnt(26)
    v_mfma_f32_16x16x32_bf16 v[60:63], v[120:123], v[204:207], v[60:63]
    v_mfma_f32_16x16x32_bf16 v[64:67], v[124:127], v[204:207], v[64:67]
    s_add_u32 s17, s12, 188416
    buffer_load_dwordx4 v[116:119], v252, s[68:71], s17 offen offset:0 sc1
    v_mfma_f32_16x16x32_bf16 v[68:71], v[128:131], v[204:207], v[68:71]
    v_mfma_f32_16x16x32_bf16 v[72:75], v[132:135], v[204:207], v[72:75]
    v_mfma_f32_16x16x32_bf16 v[76:79], v[136:139], v[204:207], v[76:79]
    s_waitcnt vmcnt(18)
    v_mfma_f32_16x16x32_bf16 v[0:3], v[140:143], v[208:211], v[0:3]
    s_add_u32 s4, s13, 40960
    buffer_load_dwordx4 v[192:195], v252, s[68:71], s4 offen sc1
    v_mfma_f32_16x16x32_bf16 v[4:7], v[144:147], v[208:211], v[4:7]
    v_mfma_f32_16x16x32_bf16 v[8:11], v[148:151], v[208:211], v[8:11]
    s_add_u32 s4, s13, 116736
    buffer_load_dwordx4 v[196:199], v252, s[68:71], s4 offen sc1
    v_mfma_f32_16x16x32_bf16 v[12:15], v[152:155], v[208:211], v[12:15]
    v_mfma_f32_16x16x32_bf16 v[16:19], v[156:159], v[208:211], v[16:19]
    s_add_u32 s4, s13, 192512
    buffer_load_dwordx4 v[200:203], v252, s[68:71], s4 offen sc1
    s_waitcnt vmcnt(21)
    v_mfma_f32_16x16x32_bf16 v[20:23], v[140:143], v[212:215], v[20:23]
    v_mfma_f32_16x16x32_bf16 v[24:27], v[144:147], v[212:215], v[24:27]
    s_add_u32 s4, s13, 268288
    buffer_load_dwordx4 v[204:207], v252, s[68:71], s4 offen sc1
    v_mfma_f32_16x16x32_bf16 v[28:31], v[148:151], v[212:215], v[28:31]
    v_mfma_f32_16x16x32_bf16 v[32:35], v[152:155], v[212:215], v[32:35]
    s_add_u32 s17, s12, 204800
    buffer_load_dwordx4 v[120:123], v252, s[68:71], s17 offen offset:0 sc1
    v_mfma_f32_16x16x32_bf16 v[36:39], v[156:159], v[212:215], v[36:39]
    s_waitcnt vmcnt(23)
    v_mfma_f32_16x16x32_bf16 v[40:43], v[140:143], v[216:219], v[40:43]
    buffer_load_dwordx4 v[124:127], v252, s[68:71], s17 offen offset:1024 sc1
    v_mfma_f32_16x16x32_bf16 v[44:47], v[144:147], v[216:219], v[44:47]
    v_mfma_f32_16x16x32_bf16 v[48:51], v[148:151], v[216:219], v[48:51]
    buffer_load_dwordx4 v[128:131], v252, s[68:71], s17 offen offset:2048 sc1
    v_mfma_f32_16x16x32_bf16 v[52:55], v[152:155], v[216:219], v[52:55]
    v_mfma_f32_16x16x32_bf16 v[56:59], v[156:159], v[216:219], v[56:59]
    buffer_load_dwordx4 v[132:135], v252, s[68:71], s17 offen offset:3072 sc1
    s_waitcnt vmcnt(26)
    v_mfma_f32_16x16x32_bf16 v[60:63], v[140:143], v[220:223], v[60:63]
    v_mfma_f32_16x16x32_bf16 v[64:67], v[144:147], v[220:223], v[64:67]
    s_add_u32 s17, s12, 208896
    buffer_load_dwordx4 v[136:139], v252, s[68:71], s17 offen offset:0 sc1
    v_mfma_f32_16x16x32_bf16 v[68:71], v[148:151], v[220:223], v[68:71]
    v_mfma_f32_16x16x32_bf16 v[72:75], v[152:155], v[220:223], v[72:75]
    v_mfma_f32_16x16x32_bf16 v[76:79], v[156:159], v[220:223], v[76:79]
    s_waitcnt vmcnt(18)
    v_mfma_f32_16x16x32_bf16 v[0:3], v[80:83], v[160:163], v[0:3]
    s_add_u32 s4, s13, 45056
    buffer_load_dwordx4 v[208:211], v252, s[68:71], s4 offen sc1
    v_mfma_f32_16x16x32_bf16 v[4:7], v[84:87], v[160:163], v[4:7]
    v_mfma_f32_16x16x32_bf16 v[8:11], v[88:91], v[160:163], v[8:11]
    s_add_u32 s4, s13, 120832
    buffer_load_dwordx4 v[212:215], v252, s[68:71], s4 offen sc1
    v_mfma_f32_16x16x32_bf16 v[12:15], v[92:95], v[160:163], v[12:15]
    v_mfma_f32_16x16x32_bf16 v[16:19], v[96:99], v[160:163], v[16:19]
    s_add_u32 s4, s13, 196608
    buffer_load_dwordx4 v[216:219], v252, s[68:71], s4 offen sc1
    s_waitcnt vmcnt(21)
    v_mfma_f32_16x16x32_bf16 v[20:23], v[80:83], v[164:167], v[20:23]
    v_mfma_f32_16x16x32_bf16 v[24:27], v[84:87], v[164:167], v[24:27]
    s_add_u32 s4, s13, 272384
    buffer_load_dwordx4 v[220:223], v252, s[68:71], s4 offen sc1
    v_mfma_f32_16x16x32_bf16 v[28:31], v[88:91], v[164:167], v[28:31]
    v_mfma_f32_16x16x32_bf16 v[32:35], v[92:95], v[164:167], v[32:35]
    s_add_u32 s17, s12, 225280
    buffer_load_dwordx4 v[140:143], v252, s[68:71], s17 offen offset:0 sc1
    v_mfma_f32_16x16x32_bf16 v[36:39], v[96:99], v[164:167], v[36:39]
    s_waitcnt vmcnt(23)
    v_mfma_f32_16x16x32_bf16 v[40:43], v[80:83], v[168:171], v[40:43]
    buffer_load_dwordx4 v[144:147], v252, s[68:71], s17 offen offset:1024 sc1
    v_mfma_f32_16x16x32_bf16 v[44:47], v[84:87], v[168:171], v[44:47]
    v_mfma_f32_16x16x32_bf16 v[48:51], v[88:91], v[168:171], v[48:51]
    buffer_load_dwordx4 v[148:151], v252, s[68:71], s17 offen offset:2048 sc1
    v_mfma_f32_16x16x32_bf16 v[52:55], v[92:95], v[168:171], v[52:55]
    v_mfma_f32_16x16x32_bf16 v[56:59], v[96:99], v[168:171], v[56:59]
    buffer_load_dwordx4 v[152:155], v252, s[68:71], s17 offen offset:3072 sc1
    s_waitcnt vmcnt(26)
    v_mfma_f32_16x16x32_bf16 v[60:63], v[80:83], v[172:175], v[60:63]
    v_mfma_f32_16x16x32_bf16 v[64:67], v[84:87], v[172:175], v[64:67]
    s_add_u32 s17, s12, 229376
    buffer_load_dwordx4 v[156:159], v252, s[68:71], s17 offen offset:0 sc1
    v_mfma_f32_16x16x32_bf16 v[68:71], v[88:91], v[172:175], v[68:71]
    v_mfma_f32_16x16x32_bf16 v[72:75], v[92:95], v[172:175], v[72:75]
    v_mfma_f32_16x16x32_bf16 v[76:79], v[96:99], v[172:175], v[76:79]
    s_waitcnt vmcnt(18)
    v_mfma_f32_16x16x32_bf16 v[0:3], v[100:103], v[176:179], v[0:3]
    s_add_u32 s4, s13, 49152
    buffer_load_dwordx4 v[160:163], v252, s[68:71], s4 offen sc1
    v_mfma_f32_16x16x32_bf16 v[4:7], v[104:107], v[176:179], v[4:7]
    v_mfma_f32_16x16x32_bf16 v[8:11], v[108:111], v[176:179], v[8:11]
    s_add_u32 s4, s13, 124928
    buffer_load_dwordx4 v[164:167], v252, s[68:71], s4 offen sc1
    v_mfma_f32_16x16x32_bf16 v[12:15], v[112:115], v[176:179], v[12:15]
    v_mfma_f32_16x16x32_bf16 v[16:19], v[116:119], v[176:179], v[16:19]
    s_add_u32 s4, s13, 200704
    buffer_load_dwordx4 v[168:171], v252, s[68:71], s4 offen sc1
    s_waitcnt vmcnt(21)
    v_mfma_f32_16x16x32_bf16 v[20:23], v[100:103], v[180:183], v[20:23]
    v_mfma_f32_16x16x32_bf16 v[24:27], v[104:107], v[180:183], v[24:27]
    s_add_u32 s4, s13, 276480
    buffer_load_dwordx4 v[172:175], v252, s[68:71], s4 offen sc1
    v_mfma_f32_16x16x32_bf16 v[28:31], v[108:111], v[180:183], v[28:31]
    v_mfma_f32_16x16x32_bf16 v[32:35], v[112:115], v[180:183], v[32:35]
    s_add_u32 s17, s12, 245760
    buffer_load_dwordx4 v[80:83], v252, s[68:71], s17 offen offset:0 sc1
    v_mfma_f32_16x16x32_bf16 v[36:39], v[116:119], v[180:183], v[36:39]
    s_waitcnt vmcnt(23)
    v_mfma_f32_16x16x32_bf16 v[40:43], v[100:103], v[184:187], v[40:43]
    buffer_load_dwordx4 v[84:87], v252, s[68:71], s17 offen offset:1024 sc1
    v_mfma_f32_16x16x32_bf16 v[44:47], v[104:107], v[184:187], v[44:47]
    v_mfma_f32_16x16x32_bf16 v[48:51], v[108:111], v[184:187], v[48:51]
    buffer_load_dwordx4 v[88:91], v252, s[68:71], s17 offen offset:2048 sc1
    v_mfma_f32_16x16x32_bf16 v[52:55], v[112:115], v[184:187], v[52:55]
    v_mfma_f32_16x16x32_bf16 v[56:59], v[116:119], v[184:187], v[56:59]
    buffer_load_dwordx4 v[92:95], v252, s[68:71], s17 offen offset:3072 sc1
    s_waitcnt vmcnt(26)
    v_mfma_f32_16x16x32_bf16 v[60:63], v[100:103], v[188:191], v[60:63]
    v_mfma_f32_16x16x32_bf16 v[64:67], v[104:107], v[188:191], v[64:67]
    s_add_u32 s17, s12, 249856
    buffer_load_dwordx4 v[96:99], v252, s[68:71], s17 offen offset:0 sc1
    v_mfma_f32_16x16x32_bf16 v[68:71], v[108:111], v[188:191], v[68:71]
    v_mfma_f32_16x16x32_bf16 v[72:75], v[112:115], v[188:191], v[72:75]
    v_mfma_f32_16x16x32_bf16 v[76:79], v[116:119], v[188:191], v[76:79]
    s_waitcnt vmcnt(18)
    v_mfma_f32_16x16x32_bf16 v[0:3], v[120:123], v[192:195], v[0:3]
    s_add_u32 s4, s13, 53248
    buffer_load_dwordx4 v[176:179], v250, s[68:71], s4 offen sc1
    v_mfma_f32_16x16x32_bf16 v[4:7], v[124:127], v[192:195], v[4:7]
    v_mfma_f32_16x16x32_bf16 v[8:11], v[128:131], v[192:195], v[8:11]
    s_add_u32 s4, s13, 129024
    buffer_load_dwordx4 v[180:183], v250, s[68:71], s4 offen sc1
    v_mfma_f32_16x16x32_bf16 v[12:15], v[132:135], v[192:195], v[12:15]
    v_mfma_f32_16x16x32_bf16 v[16:19], v[136:139], v[192:195], v[16:19]
    s_add_u32 s4, s13, 204800
    buffer_load_dwordx4 v[184:187], v250, s[68:71], s4 offen sc1
    s_waitcnt vmcnt(21)
    v_mfma_f32_16x16x32_bf16 v[20:23], v[120:123], v[196:199], v[20:23]
    v_mfma_f32_16x16x32_bf16 v[24:27], v[124:127], v[196:199], v[24:27]
    s_add_u32 s4, s13, 280576
    buffer_load_dwordx4 v[188:191], v250, s[68:71], s4 offen sc1
    v_mfma_f32_16x16x32_bf16 v[28:31], v[128:131], v[196:199], v[28:31]
    v_mfma_f32_16x16x32_bf16 v[32:35], v[132:135], v[196:199], v[32:35]
    s_add_u32 s17, s12, 266240
    buffer_load_dwordx4 v[100:103], v250, s[68:71], s17 offen offset:0 sc1
    v_mfma_f32_16x16x32_bf16 v[36:39], v[136:139], v[196:199], v[36:39]
    s_waitcnt vmcnt(23)
    v_mfma_f32_16x16x32_bf16 v[40:43], v[120:123], v[200:203], v[40:43]
    buffer_load_dwordx4 v[104:107], v250, s[68:71], s17 offen offset:1024 sc1
    v_mfma_f32_16x16x32_bf16 v[44:47], v[124:127], v[200:203], v[44:47]
    v_mfma_f32_16x16x32_bf16 v[48:51], v[128:131], v[200:203], v[48:51]
    buffer_load_dwordx4 v[108:111], v250, s[68:71], s17 offen offset:2048 sc1
    v_mfma_f32_16x16x32_bf16 v[52:55], v[132:135], v[200:203], v[52:55]
    v_mfma_f32_16x16x32_bf16 v[56:59], v[136:139], v[200:203], v[56:59]
    buffer_load_dwordx4 v[112:115], v250, s[68:71], s17 offen offset:3072 sc1
    s_waitcnt vmcnt(26)
    v_mfma_f32_16x16x32_bf16 v[60:63], v[120:123], v[204:207], v[60:63]
    v_mfma_f32_16x16x32_bf16 v[64:67], v[124:127], v[204:207], v[64:67]
    s_add_u32 s17, s12, 270336
    buffer_load_dwordx4 v[116:119], v250, s[68:71], s17 offen offset:0 sc1
    v_mfma_f32_16x16x32_bf16 v[68:71], v[128:131], v[204:207], v[68:71]
    v_mfma_f32_16x16x32_bf16 v[72:75], v[132:135], v[204:207], v[72:75]
    v_mfma_f32_16x16x32_bf16 v[76:79], v[136:139], v[204:207], v[76:79]
    s_waitcnt vmcnt(18)
    v_mfma_f32_16x16x32_bf16 v[0:3], v[140:143], v[208:211], v[0:3]
    v_mfma_f32_16x16x32_bf16 v[4:7], v[144:147], v[208:211], v[4:7]
    v_mfma_f32_16x16x32_bf16 v[8:11], v[148:151], v[208:211], v[8:11]
    v_mfma_f32_16x16x32_bf16 v[12:15], v[152:155], v[208:211], v[12:15]
    v_mfma_f32_16x16x32_bf16 v[16:19], v[156:159], v[208:211], v[16:19]
    s_waitcnt vmcnt(18)
    v_mfma_f32_16x16x32_bf16 v[20:23], v[140:143], v[212:215], v[20:23]
    v_mfma_f32_16x16x32_bf16 v[24:27], v[144:147], v[212:215], v[24:27]
    v_mfma_f32_16x16x32_bf16 v[28:31], v[148:151], v[212:215], v[28:31]
    v_mfma_f32_16x16x32_bf16 v[32:35], v[152:155], v[212:215], v[32:35]
    v_mfma_f32_16x16x32_bf16 v[36:39], v[156:159], v[212:215], v[36:39]
    s_waitcnt vmcnt(18)
    v_mfma_f32_16x16x32_bf16 v[40:43], v[140:143], v[216:219], v[40:43]
    v_mfma_f32_16x16x32_bf16 v[44:47], v[144:147], v[216:219], v[44:47]
    v_mfma_f32_16x16x32_bf16 v[48:51], v[148:151], v[216:219], v[48:51]
    v_mfma_f32_16x16x32_bf16 v[52:55], v[152:155], v[216:219], v[52:55]
    v_mfma_f32_16x16x32_bf16 v[56:59], v[156:159], v[216:219], v[56:59]
    s_waitcnt vmcnt(18)
    v_mfma_f32_16x16x32_bf16 v[60:63], v[140:143], v[220:223], v[60:63]
    v_mfma_f32_16x16x32_bf16 v[64:67], v[144:147], v[220:223], v[64:67]
    v_mfma_f32_16x16x32_bf16 v[68:71], v[148:151], v[220:223], v[68:71]
    v_mfma_f32_16x16x32_bf16 v[72:75], v[152:155], v[220:223], v[72:75]
    v_mfma_f32_16x16x32_bf16 v[76:79], v[156:159], v[220:223], v[76:79]
    s_mul_i32 s4, s82, 160
    v_lshl_add_u32 v231, v253, 4, s4
    v_lshl_add_u32 v232, v253, 3, s4
    s_lshl_b32 s4, s81, 2
    s_add_u32 s4, s4, s79
    s_lshl_b32 s5, s4, 8
    s_add_u32 s5, s5, 15466504
    s_mul_i32 s16, s4, 20480
    v_lshlrev_b32 v230, 4, v254
    buffer_load_dwordx4 v[224:227], v231, s[52:55], 0 offen offset:0
    buffer_load_dwordx2 v[228:229], v232, s[52:55], 0 offen offset:128
    buffer_load_dword v230, v230, s[68:71], s5 offen sc1
    s_movk_i32 s4, 1280
    v_mad_u32_u24 v231, v254, s4, v231
    v_mad_u32_u24 v232, v254, s4, v232
    v_mov_b32 v244, 145408
    v_mov_b32 v245, 16
    s_mov_b64 exec, 1
    ds_add_u32 v244, v245
    s_mov_b64 exec, -1
    s_waitcnt vmcnt(12)
    v_mfma_f32_16x16x32_bf16 v[0:3], v[80:83], v[160:163], v[0:3]
    v_mfma_f32_16x16x32_bf16 v[4:7], v[84:87], v[160:163], v[4:7]
    v_mfma_f32_16x16x32_bf16 v[8:11], v[88:91], v[160:163], v[8:11]
    v_mfma_f32_16x16x32_bf16 v[12:15], v[92:95], v[160:163], v[12:15]
    v_mfma_f32_16x16x32_bf16 v[16:19], v[96:99], v[160:163], v[16:19]
    s_waitcnt vmcnt(12)
    v_mfma_f32_16x16x32_bf16 v[20:23], v[80:83], v[164:167], v[20:23]
    v_mfma_f32_16x16x32_bf16 v[24:27], v[84:87], v[164:167], v[24:27]
    v_mfma_f32_16x16x32_bf16 v[28:31], v[88:91], v[164:167], v[28:31]
    v_mfma_f32_16x16x32_bf16 v[32:35], v[92:95], v[164:167], v[32:35]
    v_mfma_f32_16x16x32_bf16 v[36:39], v[96:99], v[164:167], v[36:39]
    s_waitcnt vmcnt(12)
    v_mfma_f32_16x16x32_bf16 v[40:43], v[80:83], v[168:171], v[40:43]
    v_mfma_f32_16x16x32_bf16 v[44:47], v[84:87], v[168:171], v[44:47]
    v_mfma_f32_16x16x32_bf16 v[48:51], v[88:91], v[168:171], v[48:51]
    v_mfma_f32_16x16x32_bf16 v[52:55], v[92:95], v[168:171], v[52:55]
    v_mfma_f32_16x16x32_bf16 v[56:59], v[96:99], v[168:171], v[56:59]
    s_waitcnt vmcnt(12)
    v_mfma_f32_16x16x32_bf16 v[60:63], v[80:83], v[172:175], v[60:63]
    v_mfma_f32_16x16x32_bf16 v[64:67], v[84:87], v[172:175], v[64:67]
    v_mfma_f32_16x16x32_bf16 v[68:71], v[88:91], v[172:175], v[68:71]
    v_mfma_f32_16x16x32_bf16 v[72:75], v[92:95], v[172:175], v[72:75]
    v_mfma_f32_16x16x32_bf16 v[76:79], v[96:99], v[172:175], v[76:79]
    v_mov_b32 v244, 145408
    s_mov_b32 s5, 320000
L_sp5:
    ds_read_b32 v245, v244
    s_waitcnt lgkmcnt(0)
    v_cmp_gt_u32 vcc, 68, v245
    s_nop 4
    s_cbranch_vccz L_ok5
    s_sub_u32 s5, s5, 1
    s_cbranch_scc1 L_ok5
    s_sleep 1
    s_branch L_sp5
L_ok5:
    s_sub_u32 s4, s86, 0
    v_add_u32 v80, s4, v252
    s_sub_u32 s6, s86, 1024
    s_waitcnt vmcnt(3)
    v_mfma_f32_16x16x32_bf16 v[0:3], v[100:103], v[176:179], v[0:3]
    v_mfma_f32_16x16x32_bf16 v[4:7], v[104:107], v[176:179], v[4:7]
    v_mfma_f32_16x16x32_bf16 v[8:11], v[108:111], v[176:179], v[8:11]
    v_mfma_f32_16x16x32_bf16 v[12:15], v[112:115], v[176:179], v[12:15]
    v_mfma_f32_16x16x32_bf16 v[16:19], v[116:119], v[176:179], v[16:19]
    s_waitcnt vmcnt(3)
    v_mfma_f32_16x16x32_bf16 v[20:23], v[100:103], v[180:183], v[20:23]
    v_mfma_f32_16x16x32_bf16 v[24:27], v[104:107], v[180:183], v[24:27]
    v_mfma_f32_16x16x32_bf16 v[28:31], v[108:111], v[180:183], v[28:31]
    v_mfma_f32_16x16x32_bf16 v[32:35], v[112:115], v[180:183], v[32:35]
    v_mfma_f32_16x16x32_bf16 v[36:39], v[116:119], v[180:183], v[36:39]
    ds_write_b128 v80, v[8:11] offset:14336
    ds_write_b128 v80, v[12:15] offset:21504
    s_cmp_gt_u32 s79, 0
    s_cselect_b32 s4, s6, s86
    s_add_u32 s4, s4, 0
    v_add_u32 v81, s4, v252
    v_add_u32 v80, 35840, v80
    s_cmp_eq_u32 s79, 0
    s_cbranch_scc1 L_own00
    ds_write_b128 v81, v[0:3] offset:0
    ds_write_b128 v81, v[4:7] offset:7168
    ds_write_b128 v81, v[16:19] offset:28672
    s_branch L_nown00
L_own00:
    v_mov_b32 v84, v0
    v_mov_b32 v85, v1
    v_mov_b32 v86, v2
    v_mov_b32 v87, v3
    v_mov_b32 v88, v4
    v_mov_b32 v89, v5
    v_mov_b32 v90, v6
    v_mov_b32 v91, v7
    v_mov_b32 v92, v16
    v_mov_b32 v93, v17
    v_mov_b32 v94, v18
    v_mov_b32 v95, v19
L_nown00:
    s_waitcnt vmcnt(3)
    v_mfma_f32_16x16x32_bf16 v[40:43], v[100:103], v[184:187], v[40:43]
    v_mfma_f32_16x16x32_bf16 v[44:47], v[104:107], v[184:187], v[44:47]
    v_mfma_f32_16x16x32_bf16 v[48:51], v[108:111], v[184:187], v[48:51]
    v_mfma_f32_16x16x32_bf16 v[52:55], v[112:115], v[184:187], v[52:55]
    v_mfma_f32_16x16x32_bf16 v[56:59], v[116:119], v[184:187], v[56:59]
    ds_write_b128 v80, v[28:31] offset:14336
    ds_write_b128 v80, v[32:35] offset:21504
    s_cmp_gt_u32 s79, 1
    s_cselect_b32 s4, s6, s86
    s_add_u32 s4, s4, 35840
    v_add_u32 v81, s4, v252
    v_add_u32 v80, 35840, v80
    s_cmp_eq_u32 s79, 1
    s_cbranch_scc1 L_own01
    ds_write_b128 v81, v[20:23] offset:0
    ds_write_b128 v81, v[24:27] offset:7168
    ds_write_b128 v81, v[36:39] offset:28672
    s_branch L_nown01
L_own01:
    v_mov_b32 v84, v20
    v_mov_b32 v85, v21
    v_mov_b32 v86, v22
    v_mov_b32 v87, v23
    v_mov_b32 v88, v24
    v_mov_b32 v89, v25
    v_mov_b32 v90, v26
    v_mov_b32 v91, v27
    v_mov_b32 v92, v36
    v_mov_b32 v93, v37
    v_mov_b32 v94, v38
    v_mov_b32 v95, v39
L_nown01:
    s_waitcnt vmcnt(3)
    v_mfma_f32_16x16x32_bf16 v[60:63], v[100:103], v[188:191], v[60:63]
    v_mfma_f32_16x16x32_bf16 v[64:67], v[104:107], v[188:191], v[64:67]
    v_mfma_f32_16x16x32_bf16 v[68:71], v[108:111], v[188:191], v[68:71]
    v_mfma_f32_16x16x32_bf16 v[72:75], v[112:115], v[188:191], v[72:75]
    v_mfma_f32_16x16x32_bf16 v[76:79], v[116:119], v[188:191], v[76:79]
    ds_write_b128 v80, v[48:51] offset:14336
    ds_write_b128 v80, v[52:55] offset:21504
    s_cmp_gt_u32 s79, 2
    s_cselect_b32 s4, s6, s86
    s_add_u32 s4, s4, 71680
    v_add_u32 v81, s4, v252
    v_add_u32 v80, 35840, v80
    s_cmp_eq_u32 s79, 2
    s_cbranch_scc1 L_own02
    ds_write_b128 v81, v[40:43] offset:0
    ds_write_b128 v81, v[44:47] offset:7168
    ds_write_b128 v81, v[56:59] offset:28672
    s_branch L_nown02
L_own02:
    v_mov_b32 v84, v40
    v_mov_b32 v85, v41
    v_mov_b32 v86, v42
    v_mov_b32 v87, v43
    v_mov_b32 v88, v44
    v_mov_b32 v89, v45
    v_mov_b32 v90, v46
    v_mov_b32 v91, v47
    v_mov_b32 v92, v56
    v_mov_b32 v93, v57
    v_mov_b32 v94, v58
    v_mov_b32 v95, v59
L_nown02:
    ds_write_b128 v80, v[68:71] offset:14336
    ds_write_b128 v80, v[72:75] offset:21504
    s_cmp_gt_u32 s79, 3
    s_cselect_b32 s4, s6, s86
    s_add_u32 s4, s4, 107520
    v_add_u32 v81, s4, v252
    v_add_u32 v80, 35840, v80
    s_cmp_eq_u32 s79, 3
    s_cbranch_scc1 L_own03
    ds_write_b128 v81, v[60:63] offset:0
    ds_write_b128 v81, v[64:67] offset:7168
    ds_write_b128 v81, v[76:79] offset:28672
    s_branch L_nown03
L_own03:
    v_mov_b32 v84, v60
    v_mov_b32 v85, v61
    v_mov_b32 v86, v62
    v_mov_b32 v87, v63
    v_mov_b32 v88, v64
    v_mov_b32 v89, v65
    v_mov_b32 v90, v66
    v_mov_b32 v91, v67
    v_mov_b32 v92, v76
    v_mov_b32 v93, v77
    v_mov_b32 v94, v78
    v_mov_b32 v95, v79
L_nown03:
    s_mul_i32 s4, s79, 35840
    v_add_u32 v80, s4, v252
    s_waitcnt vmcnt(0)
    v_sub_f32 v230, 1.0, v230
    v_lshlrev_b32 v96, 16, v224
    v_and_b32 v97, 0xffff0000, v224
    v_lshlrev_b32 v98, 16, v225
    v_and_b32 v99, 0xffff0000, v225
    v_fmac_f32 v84, v96, v230
    v_fmac_f32 v85, v97, v230
    v_fmac_f32 v86, v98, v230
    v_fmac_f32 v87, v99, v230
    v_lshlrev_b32 v96, 16, v226
    v_and_b32 v97, 0xffff0000, v226
    v_lshlrev_b32 v98, 16, v227
    v_and_b32 v99, 0xffff0000, v227
    v_fmac_f32 v88, v96, v230
    v_fmac_f32 v89, v97, v230
    v_fmac_f32 v90, v98, v230
    v_fmac_f32 v91, v99, v230
    v_lshlrev_b32 v96, 16, v228
    v_and_b32 v97, 0xffff0000, v228
    v_lshlrev_b32 v98, 16, v229
    v_and_b32 v99, 0xffff0000, v229
    v_fmac_f32 v92, v96, v230
    v_fmac_f32 v93, v97, v230
    v_fmac_f32 v94, v98, v230
    v_fmac_f32 v95, v99, v230
    v_mov_b32 v244, 145408
    v_mov_b32 v245, 256
    s_mov_b64 exec, 1
    ds_add_u32 v244, v245
    s_mov_b64 exec, -1
    v_mov_b32 v244, 145408
    s_mov_b32 s5, 320000
L_sp6:
    ds_read_b32 v245, v244
    s_waitcnt lgkmcnt(0)
    v_cmp_gt_u32 vcc, 1092, v245
    s_nop 4
    s_cbranch_vccz L_ok6
    s_sub_u32 s5, s5, 1
    s_cbranch_scc1 L_ok6
    s_sleep 1
    s_branch L_sp6
L_ok6:
    ds_read_b128 v[96:99], v80 offset:0
    ds_read_b128 v[100:103], v80 offset:1024
    ds_read_b128 v[104:107], v80 offset:2048
    ds_read_b128 v[124:127], v80 offset:7168
    ds_read_b128 v[128:131], v80 offset:8192
    ds_read_b128 v[132:135], v80 offset:9216
    ds_read_b128 v[152:155], v80 offset:28672
    ds_read_b128 v[156:159], v80 offset:29696
    ds_read_b128 v[160:163], v80 offset:30720
    s_waitcnt lgkmcnt(6)
    v_pk_add_f32 v[84:85], v[84:85], v[96:97]
    v_pk_add_f32 v[86:87], v[86:87], v[98:99]
    v_pk_add_f32 v[100:101], v[100:101], v[104:105]
    v_pk_add_f32 v[102:103], v[102:103], v[106:107]
    v_pk_add_f32 v[84:85], v[84:85], v[100:101]
    v_pk_add_f32 v[86:87], v[86:87], v[102:103]
    s_waitcnt lgkmcnt(3)
    v_pk_add_f32 v[88:89], v[88:89], v[124:125]
    v_pk_add_f32 v[90:91], v[90:91], v[126:127]
    v_pk_add_f32 v[128:129], v[128:129], v[132:133]
    v_pk_add_f32 v[130:131], v[130:131], v[134:135]
    v_pk_add_f32 v[88:89], v[88:89], v[128:129]
    v_pk_add_f32 v[90:91], v[90:91], v[130:131]
    s_waitcnt lgkmcnt(0)
    v_pk_add_f32 v[92:93], v[92:93], v[152:153]
    v_pk_add_f32 v[94:95], v[94:95], v[154:155]
    v_pk_add_f32 v[156:157], v[156:157], v[160:161]
    v_pk_add_f32 v[158:159], v[158:159], v[162:163]
    v_pk_add_f32 v[92:93], v[92:93], v[156:157]
    v_pk_add_f32 v[94:95], v[94:95], v[158:159]
    s_waitcnt lgkmcnt(0)
    s_barrier
    ds_read_b128 v[108:111], v80 offset:3072
    ds_read_b128 v[112:115], v80 offset:4096
    ds_read_b128 v[116:119], v80 offset:5120
    ds_read_b128 v[120:123], v80 offset:6144
    ds_read_b128 v[136:139], v80 offset:10240
    ds_read_b128 v[140:143], v80 offset:11264
    ds_read_b128 v[144:147], v80 offset:12288
    ds_read_b128 v[148:151], v80 offset:13312
    ds_read_b128 v[164:167], v80 offset:31744
    ds_read_b128 v[168:171], v80 offset:32768
    ds_read_b128 v[172:175], v80 offset:33792
    ds_read_b128 v[176:179], v80 offset:34816
    s_waitcnt lgkmcnt(8)
    v_pk_add_f32 v[108:109], v[108:109], v[112:113]
    v_pk_add_f32 v[110:111], v[110:111], v[114:115]
    v_pk_add_f32 v[116:117], v[116:117], v[120:121]
    v_pk_add_f32 v[118:119], v[118:119], v[122:123]
    v_pk_add_f32 v[108:109], v[108:109], v[116:117]
    v_pk_add_f32 v[110:111], v[110:111], v[118:119]
    v_pk_add_f32 v[84:85], v[84:85], v[108:109]
    v_pk_add_f32 v[86:87], v[86:87], v[110:111]
    v_cvt_pk_bf16_f32 v84, v84, v85
    v_cvt_pk_bf16_f32 v85, v86, v87
    s_waitcnt lgkmcnt(4)
    v_pk_add_f32 v[136:137], v[136:137], v[140:141]
    v_pk_add_f32 v[138:139], v[138:139], v[142:143]
    v_pk_add_f32 v[144:145], v[144:145], v[148:149]
    v_pk_add_f32 v[146:147], v[146:147], v[150:151]
    v_pk_add_f32 v[136:137], v[136:137], v[144:145]
    v_pk_add_f32 v[138:139], v[138:139], v[146:147]
    v_pk_add_f32 v[88:89], v[88:89], v[136:137]
    v_pk_add_f32 v[90:91], v[90:91], v[138:139]
    v_cvt_pk_bf16_f32 v86, v88, v89
    v_cvt_pk_bf16_f32 v87, v90, v91
    buffer_store_dwordx4 v[84:87], v231, s[60:63], s16 offen offset:0
    s_waitcnt lgkmcnt(0)
    v_pk_add_f32 v[164:165], v[164:165], v[168:169]
    v_pk_add_f32 v[166:167], v[166:167], v[170:171]
    v_pk_add_f32 v[172:173], v[172:173], v[176:177]
    v_pk_add_f32 v[174:175], v[174:175], v[178:179]
    v_pk_add_f32 v[164:165], v[164:165], v[172:173]
    v_pk_add_f32 v[166:167], v[166:167], v[174:175]
    v_pk_add_f32 v[92:93], v[92:93], v[164:165]
    v_pk_add_f32 v[94:95], v[94:95], v[166:167]
    v_cvt_pk_bf16_f32 v92, v92, v93
    v_cvt_pk_bf16_f32 v93, v94, v95
    buffer_store_dwordx2 v[92:93], v232, s[60:63], s16 offen offset:128
    s_branch L_fin
L_roleB:
    s_lshl_b32 s19, s78, 10
    s_add_u32 s18, s88, s19
    s_add_u32 s18, s18, 55296
    s_lshl_b32 s19, s78, 8
    s_add_u32 s19, s88, s19
    s_add_u32 s19, s19, 71680
    v_mov_b32 v216, -1
    v_mov_b32 v217, -1
    v_mov_b32 v218, -1
    v_mov_b32 v219, -1
    v_mov_b32 v220, 1073741824
    v_cmp_eq_u32 vcc, 0, v253
    s_nop 1
    v_cndmask_b32 v220, v220, v252, vcc
    s_add_u32 s4, s18, 0
    s_add_u32 s5, s19, 0
    buffer_store_dwordx4 v[216:219], v252, s[68:71], s4 offen sc1
    buffer_store_dwordx4 v[216:219], v220, s[68:71], s5 offen sc1
    s_add_u32 s4, s18, 75776
    s_add_u32 s5, s19, 75776
    buffer_store_dwordx4 v[216:219], v252, s[68:71], s4 offen sc1
    buffer_store_dwordx4 v[216:219], v220, s[68:71], s5 offen sc1
    s_waitcnt vmcnt(8)
    s_barrier
    ds_read_b128 v[236:239], v246 offset:5120
    ds_read_b128 v[240:243], v246 offset:6144
    ds_read_b128 v[216:219], v244 offset:0
    ds_read_b128 v[224:227], v244 offset:512
    ds_read_b128 v[220:223], v244 offset:64
    ds_read_b128 v[228:231], v244 offset:576
    ds_read_b128 v[232:235], v245 offset:0
    s_waitcnt lgkmcnt(6)
    v_mfma_f32_16x16x32_bf16 v[192:195], v[236:239], v[0:3], 0
    v_mfma_f32_16x16x32_bf16 v[196:199], v[236:239], v[4:7], 0
    ds_read_b128 v[236:239], v246 offset:7168
    s_waitcnt lgkmcnt(1)
    v_fmac_f32 v224, v216, v233
    v_fmac_f32 v225, v217, v233
    v_fmac_f32 v226, v218, v233
    v_fmac_f32 v227, v219, v233
    v_fmac_f32 v228, v220, v233
    v_fmac_f32 v229, v221, v233
    v_fmac_f32 v230, v222, v233
    v_mfma_f32_16x16x32_bf16 v[200:203], v[240:243], v[0:3], 0
    v_mfma_f32_16x16x32_bf16 v[204:207], v[240:243], v[4:7], 0
    ds_read_b128 v[240:243], v246 offset:13312
    v_fmac_f32 v231, v223, v233
    v_fmac_f32 v224, v160, v232
    v_fmac_f32 v225, v161, v232
    v_fmac_f32 v226, v162, v232
    v_fmac_f32 v227, v163, v232
    v_fmac_f32 v228, v168, v232
    v_fmac_f32 v229, v169, v232
    v_fmac_f32 v230, v170, v232
    s_waitcnt lgkmcnt(1)
    v_mfma_f32_16x16x32_bf16 v[208:211], v[236:239], v[0:3], 0
    v_mfma_f32_16x16x32_bf16 v[212:215], v[236:239], v[4:7], 0
    s_add_u32 m0, s86, 32768
    s_add_u32 s4, s87, 98304
    buffer_load_dwordx4 v252, s[68:71], s4 offen sc1 lds
    ds_read_b128 v[236:239], v246 offset:14336
    ds_read_b128 v[0:3], v246 offset:15360
    ds_read_b128 v[4:7], v246 offset:21504
    v_fmac_f32 v231, v171, v232
    v_mul_f32 v216, v224, v224
    v_mul_f32 v217, v225, v225
    v_mul_f32 v218, v226, v226
    v_mul_f32 v219, v227, v227
    v_mul_f32 v220, v228, v228
    v_mul_f32 v221, v229, v229
    v_mul_f32 v222, v230, v230
    s_waitcnt lgkmcnt(3)
    v_mfma_f32_16x16x32_bf16 v[192:195], v[240:243], v[8:11], v[192:195]
    v_mfma_f32_16x16x32_bf16 v[196:199], v[240:243], v[12:15], v[196:199]
    ds_read_b128 v[240:243], v246 offset:22528
    v_mul_f32 v223, v231, v231
    v_fma_f32 v216, v216, s8, v248
    v_fma_f32 v217, v217, s8, v248
    v_fma_f32 v218, v218, s8, v248
    v_fma_f32 v219, v219, s8, v248
    v_fma_f32 v220, v220, s8, v248
    v_fma_f32 v221, v221, s8, v248
    v_fma_f32 v222, v222, s8, v248
    s_waitcnt lgkmcnt(3)
    v_mfma_f32_16x16x32_bf16 v[200:203], v[236:239], v[8:11], v[200:203]
    v_mfma_f32_16x16x32_bf16 v[204:207], v[236:239], v[12:15], v[204:207]
    ds_read_b128 v[236:239], v246 offset:23552
    v_fma_f32 v223, v223, s8, v248
    v_mul_f32 v216, v216, v224
    v_mul_f32 v217, v217, v225
    v_mul_f32 v218, v218, v226
    v_mul_f32 v219, v219, v227
    v_mul_f32 v220, v220, v228
    v_mul_f32 v221, v221, v229
    v_mul_f32 v222, v222, v230
    s_waitcnt lgkmcnt(3)
    v_mfma_f32_16x16x32_bf16 v[208:211], v[0:3], v[8:11], v[208:211]
    v_mfma_f32_16x16x32_bf16 v[212:215], v[0:3], v[12:15], v[212:215]
    s_add_u32 m0, s86, 40960
    s_add_u32 s4, s87, 106496
    buffer_load_dwordx4 v252, s[68:71], s4 offen sc1 lds
    ds_read_b128 v[0:3], v246 offset:29696
    ds_read_b128 v[8:11], v246 offset:30720
    ds_read_b128 v[12:15], v246 offset:31744
    v_mul_f32 v223, v223, v231
    v_exp_f32 v216, v216
    v_exp_f32 v217, v217
    v_exp_f32 v218, v218
    v_exp_f32 v219, v219
    v_exp_f32 v220, v220
    v_exp_f32 v221, v221
    v_exp_f32 v222, v222
    s_waitcnt lgkmcnt(5)
    v_mfma_f32_16x16x32_bf16 v[192:195], v[4:7], v[16:19], v[192:195]
    v_mfma_f32_16x16x32_bf16 v[196:199], v[4:7], v[20:23], v[196:199]
    ds_read_b128 v[4:7], v246 offset:37888
    v_exp_f32 v223, v223
    v_fma_f32 v216, v216, v235, v235
    v_fma_f32 v217, v217, v235, v235
    v_fma_f32 v218, v218, v235, v235
    v_fma_f32 v219, v219, v235, v235
    v_fma_f32 v220, v220, v235, v235
    v_fma_f32 v221, v221, v235, v235
    v_fma_f32 v222, v222, v235, v235
    s_waitcnt lgkmcnt(5)
    v_mfma_f32_16x16x32_bf16 v[200:203], v[240:243], v[16:19], v[200:203]
    v_mfma_f32_16x16x32_bf16 v[204:207], v[240:243], v[20:23], v[204:207]
    ds_read_b128 v[240:243], v246 offset:38912
    v_fma_f32 v223, v223, v235, v235
    v_rcp_f32 v216, v216
    v_rcp_f32 v217, v217
    v_rcp_f32 v218, v218
    v_rcp_f32 v219, v219
    v_rcp_f32 v220, v220
    v_rcp_f32 v221, v221
    v_rcp_f32 v222, v222
    s_waitcnt lgkmcnt(5)
    v_mfma_f32_16x16x32_bf16 v[208:211], v[236:239], v[16:19], v[208:211]
    v_mfma_f32_16x16x32_bf16 v[212:215], v[236:239], v[20:23], v[212:215]
    s_add_u32 m0, s86, 49152
    s_add_u32 s4, s87, 114688
    buffer_load_dwordx4 v252, s[68:71], s4 offen sc1 lds
    ds_read_b128 v[236:239], v246 offset:39936
    v_rcp_f32 v223, v223
    v_mul_f32 v224, v224, v216
    v_mul_f32 v225, v225, v217
    v_mul_f32 v226, v226, v218
    v_mul_f32 v227, v227, v219
    v_mul_f32 v228, v228, v220
    v_mul_f32 v229, v229, v221
    v_mul_f32 v230, v230, v222
    s_waitcnt lgkmcnt(5)
    v_mfma_f32_16x16x32_bf16 v[192:195], v[0:3], v[24:27], v[192:195]
    v_mfma_f32_16x16x32_bf16 v[196:199], v[0:3], v[28:31], v[196:199]
    ds_read_b128 v[16:19], v246 offset:46080
    v_mul_f32 v231, v231, v223
    v_cvt_pk_bf16_f32 v160, v224, v225
    v_cvt_pk_bf16_f32 v161, v226, v227
    v_cvt_pk_bf16_f32 v162, v228, v229
    v_cvt_pk_bf16_f32 v163, v230, v231
    s_add_u32 s5, s10, 0
    buffer_store_dwordx4 v[160:163], v247, s[68:71], s5 offen offset:0 sc1
    ds_read_b128 v[216:219], v244 offset:0
    ds_read_b128 v[224:227], v244 offset:512
    s_waitcnt lgkmcnt(7)
    v_mfma_f32_16x16x32_bf16 v[200:203], v[8:11], v[24:27], v[200:203]
    v_mfma_f32_16x16x32_bf16 v[204:207], v[8:11], v[28:31], v[204:207]
    ds_read_b128 v[20:23], v246 offset:47104
    ds_read_b128 v[220:223], v244 offset:64
    ds_read_b128 v[228:231], v244 offset:576
    ds_read_b128 v[232:235], v245 offset:256
    s_waitcnt lgkmcnt(10)
    v_mfma_f32_16x16x32_bf16 v[208:211], v[12:15], v[24:27], v[208:211]
    v_mfma_f32_16x16x32_bf16 v[212:215], v[12:15], v[28:31], v[212:215]
    s_add_u32 m0, s86, 57344
    s_add_u32 s4, s87, 122880
    buffer_load_dwordx4 v252, s[68:71], s4 offen sc1 lds
    s_add_u32 s17, s12, 276480
    buffer_load_dwordx4 v[24:27], v252, s[68:71], s17 offen offset:0 sc1
    buffer_load_dwordx4 v[28:31], v252, s[68:71], s17 offen offset:1024 sc1
    s_waitcnt vmcnt(11)
    s_barrier
    ds_read_b128 v[0:3], v246 offset:48128
    s_waitcnt lgkmcnt(1)
    v_fmac_f32 v224, v216, v233
    v_fmac_f32 v225, v217, v233
    v_fmac_f32 v226, v218, v233
    v_fmac_f32 v227, v219, v233
    v_fmac_f32 v228, v220, v233
    v_fmac_f32 v229, v221, v233
    v_fmac_f32 v230, v222, v233
    v_mfma_f32_16x16x32_bf16 v[192:195], v[4:7], v[32:35], v[192:195]
    v_mfma_f32_16x16x32_bf16 v[196:199], v[4:7], v[36:39], v[196:199]
    ds_read_b128 v[8:11], v246 offset:54272
    v_fmac_f32 v231, v223, v233
    v_fmac_f32 v224, v164, v232
    v_fmac_f32 v225, v165, v232
    v_fmac_f32 v226, v166, v232
    v_fmac_f32 v227, v167, v232
    v_fmac_f32 v228, v172, v232
    v_fmac_f32 v229, v173, v232
    v_fmac_f32 v230, v174, v232
    v_mfma_f32_16x16x32_bf16 v[200:203], v[240:243], v[32:35], v[200:203]
    v_mfma_f32_16x16x32_bf16 v[204:207], v[240:243], v[36:39], v[204:207]
    ds_read_b128 v[12:15], v246 offset:55296
    v_fmac_f32 v231, v175, v232
    v_mul_f32 v216, v224, v224
    v_mul_f32 v217, v225, v225
    v_mul_f32 v218, v226, v226
    v_mul_f32 v219, v227, v227
    v_mul_f32 v220, v228, v228
    v_mul_f32 v221, v229, v229
    v_mul_f32 v222, v230, v230
    v_mfma_f32_16x16x32_bf16 v[208:211], v[236:239], v[32:35], v[208:211]
    v_mfma_f32_16x16x32_bf16 v[212:215], v[236:239], v[36:39], v[212:215]
    s_add_u32 m0, s86, 65536
    s_add_u32 s4, s87, 131072
    buffer_load_dwordx4 v252, s[68:71], s4 offen sc1 lds
    buffer_load_dwordx4 v[32:35], v252, s[68:71], s17 offen offset:2048 sc1
    buffer_load_dwordx4 v[36:39], v252, s[68:71], s17 offen offset:3072 sc1
    ds_read_b128 v[4:7], v246 offset:56320
    v_mul_f32 v223, v231, v231
    v_fma_f32 v216, v216, s8, v248
    v_fma_f32 v217, v217, s8, v248
    v_fma_f32 v218, v218, s8, v248
    v_fma_f32 v219, v219, s8, v248
    v_fma_f32 v220, v220, s8, v248
    v_fma_f32 v221, v221, s8, v248
    v_fma_f32 v222, v222, s8, v248
    v_mfma_f32_16x16x32_bf16 v[192:195], v[16:19], v[40:43], v[192:195]
    v_mfma_f32_16x16x32_bf16 v[196:199], v[16:19], v[44:47], v[196:199]
    ds_read_b128 v[240:243], v246 offset:62464
    v_fma_f32 v223, v223, s8, v248
    v_mul_f32 v216, v216, v224
    v_mul_f32 v217, v217, v225
    v_mul_f32 v218, v218, v226
    v_mul_f32 v219, v219, v227
    v_mul_f32 v220, v220, v228
    v_mul_f32 v221, v221, v229
    v_mul_f32 v222, v222, v230
    v_mfma_f32_16x16x32_bf16 v[200:203], v[20:23], v[40:43], v[200:203]
    v_mfma_f32_16x16x32_bf16 v[204:207], v[20:23], v[44:47], v[204:207]
    ds_read_b128 v[236:239], v246 offset:63488
    v_mul_f32 v223, v223, v231
    v_exp_f32 v216, v216
    v_exp_f32 v217, v217
    v_exp_f32 v218, v218
    v_exp_f32 v219, v219
    v_exp_f32 v220, v220
    v_exp_f32 v221, v221
    v_exp_f32 v222, v222
    s_waitcnt lgkmcnt(5)
    v_mfma_f32_16x16x32_bf16 v[208:211], v[0:3], v[40:43], v[208:211]
    v_mfma_f32_16x16x32_bf16 v[212:215], v[0:3], v[44:47], v[212:215]
    s_add_u32 m0, s86, 73728
    s_add_u32 s4, s87, 139264
    buffer_load_dwordx4 v252, s[68:71], s4 offen sc1 lds
    s_add_u32 s17, s12, 280576
    buffer_load_dwordx4 v[40:43], v252, s[68:71], s17 offen offset:0 sc1
    s_add_u32 s17, s12, 296960
    buffer_load_dwordx4 v[44:47], v252, s[68:71], s17 offen offset:0 sc1
    ds_read_b128 v[16:19], v246 offset:64512
    v_exp_f32 v223, v223
    v_fma_f32 v216, v216, v235, v235
    v_fma_f32 v217, v217, v235, v235
    v_fma_f32 v218, v218, v235, v235
    v_fma_f32 v219, v219, v235, v235
    v_fma_f32 v220, v220, v235, v235
    v_fma_f32 v221, v221, v235, v235
    v_fma_f32 v222, v222, v235, v235
    s_waitcnt lgkmcnt(5)
    v_mfma_f32_16x16x32_bf16 v[192:195], v[8:11], v[48:51], v[192:195]
    v_mfma_f32_16x16x32_bf16 v[196:199], v[8:11], v[52:55], v[196:199]
    ds_read_b128 v[20:23], v252 offset:5120
    v_fma_f32 v223, v223, v235, v235
    v_rcp_f32 v216, v216
    v_rcp_f32 v217, v217
    v_rcp_f32 v218, v218
    v_rcp_f32 v219, v219
    v_rcp_f32 v220, v220
    v_rcp_f32 v221, v221
    v_rcp_f32 v222, v222
    s_waitcnt lgkmcnt(5)
    v_mfma_f32_16x16x32_bf16 v[200:203], v[12:15], v[48:51], v[200:203]
    v_mfma_f32_16x16x32_bf16 v[204:207], v[12:15], v[52:55], v[204:207]
    ds_read_b128 v[0:3], v252 offset:6144
    v_rcp_f32 v223, v223
    v_mul_f32 v224, v224, v216
    v_mul_f32 v225, v225, v217
    v_mul_f32 v226, v226, v218
    v_mul_f32 v227, v227, v219
    v_mul_f32 v228, v228, v220
    v_mul_f32 v229, v229, v221
    v_mul_f32 v230, v230, v222
    s_waitcnt lgkmcnt(5)
    v_mfma_f32_16x16x32_bf16 v[208:211], v[4:7], v[48:51], v[208:211]
    v_mfma_f32_16x16x32_bf16 v[212:215], v[4:7], v[52:55], v[212:215]
    s_add_u32 m0, s86, 81920
    s_add_u32 s4, s87, 147456
    buffer_load_dwordx4 v252, s[68:71], s4 offen sc1 lds
    buffer_load_dwordx4 v[48:51], v252, s[68:71], s17 offen offset:1024 sc1
    buffer_load_dwordx4 v[52:55], v252, s[68:71], s17 offen offset:2048 sc1
    ds_read_b128 v[8:11], v252 offset:7168
    v_mul_f32 v231, v231, v223
    v_cvt_pk_bf16_f32 v164, v224, v225
    v_cvt_pk_bf16_f32 v165, v226, v227
    v_cvt_pk_bf16_f32 v166, v228, v229
    v_cvt_pk_bf16_f32 v167, v230, v231
    s_add_u32 s5, s10, 75776
    buffer_store_dwordx4 v[164:167], v247, s[68:71], s5 offen offset:0 sc1
    ds_read_b128 v[216:219], v244 offset:128
    ds_read_b128 v[224:227], v244 offset:640
    s_waitcnt lgkmcnt(7)
    v_mfma_f32_16x16x32_bf16 v[192:195], v[240:243], v[56:59], v[192:195]
    v_mfma_f32_16x16x32_bf16 v[196:199], v[240:243], v[60:63], v[196:199]
    ds_read_b128 v[12:15], v252 offset:13312
    ds_read_b128 v[220:223], v244 offset:192
    ds_read_b128 v[228:231], v244 offset:704
    ds_read_b128 v[232:235], v245 offset:0
    s_waitcnt lgkmcnt(10)
    v_mfma_f32_16x16x32_bf16 v[200:203], v[236:239], v[56:59], v[200:203]
    v_mfma_f32_16x16x32_bf16 v[204:207], v[236:239], v[60:63], v[204:207]
    ds_read_b128 v[4:7], v252 offset:14336
    s_waitcnt lgkmcnt(1)
    v_fmac_f32 v224, v216, v233
    v_fmac_f32 v225, v217, v233
    v_fmac_f32 v226, v218, v233
    v_fmac_f32 v227, v219, v233
    v_fmac_f32 v228, v220, v233
    v_fmac_f32 v229, v221, v233
    v_fmac_f32 v230, v222, v233
    v_mfma_f32_16x16x32_bf16 v[208:211], v[16:19], v[56:59], v[208:211]
    v_mfma_f32_16x16x32_bf16 v[212:215], v[16:19], v[60:63], v[212:215]
    s_add_u32 m0, s86, 90112
    s_add_u32 s4, s87, 155648
    buffer_load_dwordx4 v252, s[68:71], s4 offen sc1 lds
    buffer_load_dwordx4 v[56:59], v252, s[68:71], s17 offen offset:3072 sc1
    s_add_u32 s17, s12, 301056
    buffer_load_dwordx4 v[60:63], v252, s[68:71], s17 offen offset:0 sc1
    s_waitcnt vmcnt(15)
    s_barrier
    ds_read_b128 v[240:243], v252 offset:15360
    v_fmac_f32 v231, v223, v233
    v_fmac_f32 v224, v176, v232
    v_fmac_f32 v225, v177, v232
    v_fmac_f32 v226, v178, v232
    v_fmac_f32 v227, v179, v232
    v_fmac_f32 v228, v184, v232
    v_fmac_f32 v229, v185, v232
    v_fmac_f32 v230, v186, v232
    v_mfma_f32_16x16x32_bf16 v[192:195], v[20:23], v[64:67], v[192:195]
    v_mfma_f32_16x16x32_bf16 v[196:199], v[20:23], v[68:71], v[196:199]
    ds_read_b128 v[236:239], v252 offset:21504
    v_fmac_f32 v231, v187, v232
    v_mul_f32 v216, v224, v224
    v_mul_f32 v217, v225, v225
    v_mul_f32 v218, v226, v226
    v_mul_f32 v219, v227, v227
    v_mul_f32 v220, v228, v228
    v_mul_f32 v221, v229, v229
    v_mul_f32 v222, v230, v230
    v_mfma_f32_16x16x32_bf16 v[200:203], v[0:3], v[64:67], v[200:203]
    v_mfma_f32_16x16x32_bf16 v[204:207], v[0:3], v[68:71], v[204:207]
    ds_read_b128 v[16:19], v252 offset:22528
    v_mul_f32 v223, v231, v231
    v_fma_f32 v216, v216, s8, v248
    v_fma_f32 v217, v217, s8, v248
    v_fma_f32 v218, v218, s8, v248
    v_fma_f32 v219, v219, s8, v248
    v_fma_f32 v220, v220, s8, v248
    v_fma_f32 v221, v221, s8, v248
    v_fma_f32 v222, v222, s8, v248
    v_mfma_f32_16x16x32_bf16 v[208:211], v[8:11], v[64:67], v[208:211]
    v_mfma_f32_16x16x32_bf16 v[212:215], v[8:11], v[68:71], v[212:215]
    s_add_u32 s17, s12, 317440
    buffer_load_dwordx4 v[64:67], v252, s[68:71], s17 offen offset:0 sc1
    buffer_load_dwordx4 v[68:71], v252, s[68:71], s17 offen offset:1024 sc1
    ds_read_b128 v[20:23], v252 offset:23552
    v_fma_f32 v223, v223, s8, v248
    v_mul_f32 v216, v216, v224
    v_mul_f32 v217, v217, v225
    v_mul_f32 v218, v218, v226
    v_mul_f32 v219, v219, v227
    v_mul_f32 v220, v220, v228
    v_mul_f32 v221, v221, v229
    v_mul_f32 v222, v222, v230
    v_mfma_f32_16x16x32_bf16 v[192:195], v[12:15], v[72:75], v[192:195]
    v_mfma_f32_16x16x32_bf16 v[196:199], v[12:15], v[76:79], v[196:199]
    ds_read_b128 v[0:3], v252 offset:29696
    v_mul_f32 v223, v223, v231
    v_exp_f32 v216, v216
    v_exp_f32 v217, v217
    v_exp_f32 v218, v218
    v_exp_f32 v219, v219
    v_exp_f32 v220, v220
    v_exp_f32 v221, v221
    v_exp_f32 v222, v222
    s_waitcnt lgkmcnt(5)
    v_mfma_f32_16x16x32_bf16 v[200:203], v[4:7], v[72:75], v[200:203]
    v_mfma_f32_16x16x32_bf16 v[204:207], v[4:7], v[76:79], v[204:207]
    ds_read_b128 v[8:11], v252 offset:30720
    v_exp_f32 v223, v223
    v_fma_f32 v216, v216, v235, v235
    v_fma_f32 v217, v217, v235, v235
    v_fma_f32 v218, v218, v235, v235
    v_fma_f32 v219, v219, v235, v235
    v_fma_f32 v220, v220, v235, v235
    v_fma_f32 v221, v221, v235, v235
    v_fma_f32 v222, v222, v235, v235
    s_waitcnt lgkmcnt(5)
    v_mfma_f32_16x16x32_bf16 v[208:211], v[240:243], v[72:75], v[208:211]
    v_mfma_f32_16x16x32_bf16 v[212:215], v[240:243], v[76:79], v[212:215]
    buffer_load_dwordx4 v[72:75], v252, s[68:71], s17 offen offset:2048 sc1
    buffer_load_dwordx4 v[76:79], v252, s[68:71], s17 offen offset:3072 sc1
    ds_read_b128 v[12:15], v252 offset:31744
    v_fma_f32 v223, v223, v235, v235
    v_rcp_f32 v216, v216
    v_rcp_f32 v217, v217
    v_rcp_f32 v218, v218
    v_rcp_f32 v219, v219
    v_rcp_f32 v220, v220
    v_rcp_f32 v221, v221
    v_rcp_f32 v222, v222
    s_waitcnt lgkmcnt(5)
    v_mfma_f32_16x16x32_bf16 v[192:195], v[236:239], v[80:83], v[192:195]
    v_mfma_f32_16x16x32_bf16 v[196:199], v[236:239], v[84:87], v[196:199]
    ds_read_b128 v[4:7], v252 offset:37888
    v_rcp_f32 v223, v223
    v_mul_f32 v224, v224, v216
    v_mul_f32 v225, v225, v217
    v_mul_f32 v226, v226, v218
    v_mul_f32 v227, v227, v219
    v_mul_f32 v228, v228, v220
    v_mul_f32 v229, v229, v221
    v_mul_f32 v230, v230, v222
    s_waitcnt lgkmcnt(5)
    v_mfma_f32_16x16x32_bf16 v[200:203], v[16:19], v[80:83], v[200:203]
    v_mfma_f32_16x16x32_bf16 v[204:207], v[16:19], v[84:87], v[204:207]
    ds_read_b128 v[240:243], v252 offset:38912
    v_mul_f32 v231, v231, v223
    v_cvt_pk_bf16_f32 v176, v224, v225
    v_cvt_pk_bf16_f32 v177, v226, v227
    v_cvt_pk_bf16_f32 v178, v228, v229
    v_cvt_pk_bf16_f32 v179, v230, v231
    s_add_u32 s5, s10, 0
    buffer_store_dwordx4 v[176:179], v247, s[68:71], s5 offen offset:1024 sc1
    ds_read_b128 v[216:219], v244 offset:128
    ds_read_b128 v[224:227], v244 offset:640
    s_waitcnt lgkmcnt(7)
    v_mfma_f32_16x16x32_bf16 v[208:211], v[20:23], v[80:83], v[208:211]
    v_mfma_f32_16x16x32_bf16 v[212:215], v[20:23], v[84:87], v[212:215]
    s_add_u32 s17, s12, 321536
    buffer_load_dwordx4 v[80:83], v252, s[68:71], s17 offen offset:0 sc1
    s_add_u32 s17, s12, 337920
    buffer_load_dwordx4 v[84:87], v252, s[68:71], s17 offen offset:0 sc1
    ds_read_b128 v[236:239], v252 offset:39936
    ds_read_b128 v[220:223], v244 offset:192
    ds_read_b128 v[228:231], v244 offset:704
    ds_read_b128 v[232:235], v245 offset:256
    s_waitcnt lgkmcnt(10)
    v_mfma_f32_16x16x32_bf16 v[192:195], v[0:3], v[88:91], v[192:195]
    v_mfma_f32_16x16x32_bf16 v[196:199], v[0:3], v[92:95], v[196:199]
    ds_read_b128 v[16:19], v252 offset:46080
    s_waitcnt lgkmcnt(1)
    v_fmac_f32 v224, v216, v233
    v_fmac_f32 v225, v217, v233
    v_fmac_f32 v226, v218, v233
    v_fmac_f32 v227, v219, v233
    v_fmac_f32 v228, v220, v233
    v_fmac_f32 v229, v221, v233
    v_fmac_f32 v230, v222, v233
    v_mfma_f32_16x16x32_bf16 v[200:203], v[8:11], v[88:91], v[200:203]
    v_mfma_f32_16x16x32_bf16 v[204:207], v[8:11], v[92:95], v[204:207]
    ds_read_b128 v[20:23], v252 offset:47104
    v_fmac_f32 v231, v223, v233
    v_fmac_f32 v224, v180, v232
    v_fmac_f32 v225, v181, v232
    v_fmac_f32 v226, v182, v232
    v_fmac_f32 v227, v183, v232
    v_fmac_f32 v228, v188, v232
    v_fmac_f32 v229, v189, v232
    v_fmac_f32 v230, v190, v232
    v_mfma_f32_16x16x32_bf16 v[208:211], v[12:15], v[88:91], v[208:211]
    v_mfma_f32_16x16x32_bf16 v[212:215], v[12:15], v[92:95], v[212:215]
    buffer_load_dwordx4 v[88:91], v252, s[68:71], s17 offen offset:1024 sc1
    buffer_load_dwordx4 v[92:95], v252, s[68:71], s17 offen offset:2048 sc1
    s_waitcnt vmcnt(11)
    s_barrier
    ds_read_b128 v[0:3], v252 offset:48128
    v_fmac_f32 v231, v191, v232
    v_mul_f32 v216, v224, v224
    v_mul_f32 v217, v225, v225
    v_mul_f32 v218, v226, v226
    v_mul_f32 v219, v227, v227
    v_mul_f32 v220, v228, v228
    v_mul_f32 v221, v229, v229
    v_mul_f32 v222, v230, v230
    v_mfma_f32_16x16x32_bf16 v[192:195], v[4:7], v[96:99], v[192:195]
    v_mfma_f32_16x16x32_bf16 v[196:199], v[4:7], v[100:103], v[196:199]
    ds_read_b128 v[8:11], v252 offset:54272
    v_mul_f32 v223, v231, v231
    v_fma_f32 v216, v216, s8, v248
    v_fma_f32 v217, v217, s8, v248
    v_fma_f32 v218, v218, s8, v248
    v_fma_f32 v219, v219, s8, v248
    v_fma_f32 v220, v220, s8, v248
    v_fma_f32 v221, v221, s8, v248
    v_fma_f32 v222, v222, s8, v248
    v_mfma_f32_16x16x32_bf16 v[200:203], v[240:243], v[96:99], v[200:203]
    v_mfma_f32_16x16x32_bf16 v[204:207], v[240:243], v[100:103], v[204:207]
    ds_read_b128 v[12:15], v252 offset:55296
    v_fma_f32 v223, v223, s8, v248
    v_mul_f32 v216, v216, v224
    v_mul_f32 v217, v217, v225
    v_mul_f32 v218, v218, v226
    v_mul_f32 v219, v219, v227
    v_mul_f32 v220, v220, v228
    v_mul_f32 v221, v221, v229
    v_mul_f32 v222, v222, v230
    v_mfma_f32_16x16x32_bf16 v[208:211], v[236:239], v[96:99], v[208:211]
    v_mfma_f32_16x16x32_bf16 v[212:215], v[236:239], v[100:103], v[212:215]
    buffer_load_dwordx4 v[96:99], v252, s[68:71], s17 offen offset:3072 sc1
    s_add_u32 s17, s12, 342016
    buffer_load_dwordx4 v[100:103], v252, s[68:71], s17 offen offset:0 sc1
    ds_read_b128 v[4:7], v252 offset:56320
    v_mul_f32 v223, v223, v231
    v_exp_f32 v216, v216
    v_exp_f32 v217, v217
    v_exp_f32 v218, v218
    v_exp_f32 v219, v219
    v_exp_f32 v220, v220
    v_exp_f32 v221, v221
    v_exp_f32 v222, v222
    s_waitcnt lgkmcnt(5)
    v_mfma_f32_16x16x32_bf16 v[192:195], v[16:19], v[104:107], v[192:195]
    v_mfma_f32_16x16x32_bf16 v[196:199], v[16:19], v[108:111], v[196:199]
    ds_read_b128 v[240:243], v252 offset:62464
    v_exp_f32 v223, v223
    v_fma_f32 v216, v216, v235, v235
    v_fma_f32 v217, v217, v235, v235
    v_fma_f32 v218, v218, v235, v235
    v_fma_f32 v219, v219, v235, v235
    v_fma_f32 v220, v220, v235, v235
    v_fma_f32 v221, v221, v235, v235
    v_fma_f32 v222, v222, v235, v235
    s_waitcnt lgkmcnt(5)
    v_mfma_f32_16x16x32_bf16 v[200:203], v[20:23], v[104:107], v[200:203]
    v_mfma_f32_16x16x32_bf16 v[204:207], v[20:23], v[108:111], v[204:207]
    ds_read_b128 v[236:239], v252 offset:63488
    v_fma_f32 v223, v223, v235, v235
    v_rcp_f32 v216, v216
    v_rcp_f32 v217, v217
    v_rcp_f32 v218, v218
    v_rcp_f32 v219, v219
    v_rcp_f32 v220, v220
    v_rcp_f32 v221, v221
    v_rcp_f32 v222, v222
    s_waitcnt lgkmcnt(5)
    v_mfma_f32_16x16x32_bf16 v[208:211], v[0:3], v[104:107], v[208:211]
    v_mfma_f32_16x16x32_bf16 v[212:215], v[0:3], v[108:111], v[212:215]
    s_add_u32 s17, s12, 358400
    buffer_load_dwordx4 v[104:107], v252, s[68:71], s17 offen offset:0 sc1
    buffer_load_dwordx4 v[108:111], v252, s[68:71], s17 offen offset:1024 sc1
    ds_read_b128 v[16:19], v252 offset:64512
    v_rcp_f32 v223, v223
    v_mul_f32 v224, v224, v216
    v_mul_f32 v225, v225, v217
    v_mul_f32 v226, v226, v218
    v_mul_f32 v227, v227, v219
    v_mul_f32 v228, v228, v220
    v_mul_f32 v229, v229, v221
    v_mul_f32 v230, v230, v222
    s_waitcnt lgkmcnt(5)
    v_mfma_f32_16x16x32_bf16 v[192:195], v[8:11], v[112:115], v[192:195]
    v_mfma_f32_16x16x32_bf16 v[196:199], v[8:11], v[116:119], v[196:199]
    ds_read_b128 v[20:23], v246 offset:5120
    v_mul_f32 v231, v231, v223
    v_cvt_pk_bf16_f32 v180, v224, v225
    v_cvt_pk_bf16_f32 v181, v226, v227
    v_cvt_pk_bf16_f32 v182, v228, v229
    v_cvt_pk_bf16_f32 v183, v230, v231
    s_add_u32 s5, s10, 75776
    buffer_store_dwordx4 v[180:183], v247, s[68:71], s5 offen offset:1024 sc1
    s_waitcnt lgkmcnt(5)
    v_mfma_f32_16x16x32_bf16 v[200:203], v[12:15], v[112:115], v[200:203]
    v_mfma_f32_16x16x32_bf16 v[204:207], v[12:15], v[116:119], v[204:207]
    ds_read_b128 v[0:3], v246 offset:6144
    s_waitcnt lgkmcnt(5)
    v_mfma_f32_16x16x32_bf16 v[208:211], v[4:7], v[112:115], v[208:211]
    v_mfma_f32_16x16x32_bf16 v[212:215], v[4:7], v[116:119], v[212:215]
    buffer_load_dwordx4 v[112:115], v252, s[68:71], s17 offen offset:2048 sc1
    buffer_load_dwordx4 v[116:119], v252, s[68:71], s17 offen offset:3072 sc1
    ds_read_b128 v[8:11], v246 offset:7168
    s_waitcnt lgkmcnt(5)
    v_mfma_f32_16x16x32_bf16 v[192:195], v[240:243], v[120:123], v[192:195]
    v_mfma_f32_16x16x32_bf16 v[196:199], v[240:243], v[124:127], v[196:199]
    ds_read_b128 v[12:15], v246 offset:13312
    s_waitcnt lgkmcnt(5)
    v_mfma_f32_16x16x32_bf16 v[200:203], v[236:239], v[120:123], v[200:203]
    v_mfma_f32_16x16x32_bf16 v[204:207], v[236:239], v[124:127], v[204:207]
    ds_read_b128 v[4:7], v246 offset:14336
    s_waitcnt lgkmcnt(5)
    v_mfma_f32_16x16x32_bf16 v[208:211], v[16:19], v[120:123], v[208:211]
    v_mfma_f32_16x16x32_bf16 v[212:215], v[16:19], v[124:127], v[212:215]
    s_add_u32 s17, s12, 362496
    buffer_load_dwordx4 v[120:123], v252, s[68:71], s17 offen offset:0 sc1
    s_waitcnt vmcnt(3)
    s_barrier
    s_cmp_lg_u32 s79, 0
    s_cbranch_scc1 L_nsH
    s_lshl_b32 s4, s77, 8
    s_add_u32 s4, s4, 15695872
    v_mov_b32 v250, 1
    v_mov_b32 v251, 0
    s_mov_b64 exec, 1
    buffer_atomic_add v250, v251, s[68:71], s4 offen sc1
    s_mov_b64 exec, -1
L_nsH:
    ds_read_b128 v[240:243], v246 offset:15360
    s_waitcnt lgkmcnt(5)
    v_mfma_f32_16x16x32_bf16 v[192:195], v[20:23], v[128:131], v[192:195]
    v_mfma_f32_16x16x32_bf16 v[196:199], v[20:23], v[132:135], v[196:199]
    ds_read_b128 v[236:239], v246 offset:21504
    s_waitcnt lgkmcnt(5)
    v_mfma_f32_16x16x32_bf16 v[200:203], v[0:3], v[128:131], v[200:203]
    v_mfma_f32_16x16x32_bf16 v[204:207], v[0:3], v[132:135], v[204:207]
    ds_read_b128 v[16:19], v246 offset:22528
    s_waitcnt lgkmcnt(5)
    v_mfma_f32_16x16x32_bf16 v[208:211], v[8:11], v[128:131], v[208:211]
    v_mfma_f32_16x16x32_bf16 v[212:215], v[8:11], v[132:135], v[212:215]
    ds_read_b128 v[20:23], v246 offset:23552
    s_waitcnt lgkmcnt(5)
    v_mfma_f32_16x16x32_bf16 v[192:195], v[12:15], v[136:139], v[192:195]
    v_mfma_f32_16x16x32_bf16 v[196:199], v[12:15], v[140:143], v[196:199]
    ds_read_b128 v[0:3], v246 offset:29696
    s_waitcnt lgkmcnt(5)
    v_mfma_f32_16x16x32_bf16 v[200:203], v[4:7], v[136:139], v[200:203]
    v_mfma_f32_16x16x32_bf16 v[204:207], v[4:7], v[140:143], v[204:207]
    ds_read_b128 v[8:11], v246 offset:30720
    s_waitcnt lgkmcnt(5)
    v_mfma_f32_16x16x32_bf16 v[208:211], v[240:243], v[136:139], v[208:211]
    v_mfma_f32_16x16x32_bf16 v[212:215], v[240:243], v[140:143], v[212:215]
    ds_read_b128 v[12:15], v246 offset:31744
    s_waitcnt lgkmcnt(5)
    v_mfma_f32_16x16x32_bf16 v[192:195], v[236:239], v[144:147], v[192:195]
    v_mfma_f32_16x16x32_bf16 v[196:199], v[236:239], v[148:151], v[196:199]
    s_waitcnt lgkmcnt(4)
    v_mfma_f32_16x16x32_bf16 v[200:203], v[16:19], v[144:147], v[200:203]
    v_mfma_f32_16x16x32_bf16 v[204:207], v[16:19], v[148:151], v[204:207]
    s_waitcnt lgkmcnt(3)
    v_mfma_f32_16x16x32_bf16 v[208:211], v[20:23], v[144:147], v[208:211]
    v_mfma_f32_16x16x32_bf16 v[212:215], v[20:23], v[148:151], v[212:215]
    s_waitcnt lgkmcnt(2)
    v_mfma_f32_16x16x32_bf16 v[192:195], v[0:3], v[152:155], v[192:195]
    v_mfma_f32_16x16x32_bf16 v[196:199], v[0:3], v[156:159], v[196:199]
    s_waitcnt lgkmcnt(1)
    v_mfma_f32_16x16x32_bf16 v[200:203], v[8:11], v[152:155], v[200:203]
    v_mfma_f32_16x16x32_bf16 v[204:207], v[8:11], v[156:159], v[204:207]
    s_waitcnt lgkmcnt(0)
    v_mfma_f32_16x16x32_bf16 v[208:211], v[12:15], v[152:155], v[208:211]
    v_mfma_f32_16x16x32_bf16 v[212:215], v[12:15], v[156:159], v[212:215]
    s_add_u32 s20, s79, 2
    s_and_b32 s21, s79, 2
    s_add_u32 s20, s20, s21
    s_lshl_b32 s20, s20, 14
    s_lshl_b32 s21, s79, 13
    s_add_u32 s21, s21, 65536
    s_lshl_b32 s22, s79, 2
    s_add_u32 s22, s22, 145440
    s_add_u32 m0, s20, 0
    s_add_u32 s17, s12, 81920
    buffer_load_dwordx4 v252, s[68:71], s17 offen sc1 lds
    s_add_u32 m0, s20, 1024
    s_add_u32 s17, s12, 82944
    buffer_load_dwordx4 v252, s[68:71], s17 offen sc1 lds
    s_add_u32 m0, s20, 2048
    s_add_u32 s17, s12, 83968
    buffer_load_dwordx4 v252, s[68:71], s17 offen sc1 lds
    s_add_u32 m0, s20, 3072
    s_add_u32 s17, s12, 84992
    buffer_load_dwordx4 v252, s[68:71], s17 offen sc1 lds
    s_add_u32 m0, s20, 4096
    s_add_u32 s17, s12, 86016
    buffer_load_dwordx4 v252, s[68:71], s17 offen sc1 lds
    s_add_u32 m0, s20, 5120
    s_add_u32 s17, s12, 102400
    buffer_load_dwordx4 v252, s[68:71], s17 offen sc1 lds
    s_add_u32 m0, s20, 6144
    s_add_u32 s17, s12, 103424
    buffer_load_dwordx4 v252, s[68:71], s17 offen sc1 lds
    s_add_u32 m0, s20, 7168
    s_add_u32 s17, s12, 104448
    buffer_load_dwordx4 v252, s[68:71], s17 offen sc1 lds
    s_add_u32 m0, s20, 8192
    s_add_u32 s17, s12, 105472
    buffer_load_dwordx4 v252, s[68:71], s17 offen sc1 lds
    s_add_u32 m0, s20, 9216
    s_add_u32 s17, s12, 106496
    buffer_load_dwordx4 v252, s[68:71], s17 offen sc1 lds
    s_add_u32 m0, s20, 10240
    s_add_u32 s17, s12, 122880
    buffer_load_dwordx4 v252, s[68:71], s17 offen sc1 lds
    s_add_u32 m0, s20, 11264
    s_add_u32 s17, s12, 123904
    buffer_load_dwordx4 v252, s[68:71], s17 offen sc1 lds
    s_add_u32 m0, s20, 12288
    s_add_u32 s17, s12, 124928
    buffer_load_dwordx4 v252, s[68:71], s17 offen sc1 lds
    s_add_u32 m0, s20, 13312
    s_add_u32 s17, s12, 125952
    buffer_load_dwordx4 v252, s[68:71], s17 offen sc1 lds
    s_add_u32 m0, s20, 14336
    s_add_u32 s17, s12, 126976
    buffer_load_dwordx4 v252, s[68:71], s17 offen sc1 lds
    s_lshl_b32 s14, s78, 6
    s_add_u32 s14, s14, s79
    s_lshl_b32 s14, s14, 10
    s_add_u32 s14, s14, 15990784
    s_lshl_b32 s4, s79, 6
    v_add_u32 v23, s4, v255
    v_lshlrev_b32 v16, 4, v23
    v_mov_b32 v19, 1073741824
    v_cmp_gt_u32 vcc, 210, v23
    s_nop 1
    v_cndmask_b32 v17, v19, v252, vcc
    s_lshl_b32 s3, s77, 12
    s_add_u32 s3, s3, s14
    s_setprio 3
    s_barrier
    ds_read_b128 v[148:151], v16 offset:0
    ds_read_b128 v[152:155], v16 offset:8192
    ds_read_b128 v[156:159], v16 offset:16384
    ds_read_b128 v[160:163], v16 offset:24576
    ds_read_b128 v[236:239], v245
    ds_read_b128 v[240:243], v245 offset:256
    s_waitcnt lgkmcnt(0)
    v_pk_add_f32 v[148:149], v[148:149], v[152:153]
    v_pk_add_f32 v[150:151], v[150:151], v[154:155]
    v_pk_add_f32 v[156:157], v[156:157], v[160:161]
    v_pk_add_f32 v[158:159], v[158:159], v[162:163]
    v_pk_add_f32 v[148:149], v[148:149], v[156:157]
    v_pk_add_f32 v[150:151], v[150:151], v[158:159]
    buffer_store_dwordx4 v[148:151], v17, s[68:71], s3 offen sc1
    s_setprio 0
    s_mov_b32 s8, 0x3fb8aa3b
    s_mov_b32 s9, s8
    s_mov_b32 s6, 0x358637bd
    s_mov_b32 s7, s6
    v_pk_mul_f32 v[124:125], v[192:193], s[8:9]
    v_pk_mul_f32 v[126:127], v[194:195], s[8:9]
    v_pk_mul_f32 v[128:129], v[200:201], s[8:9]
    v_pk_mul_f32 v[130:131], v[202:203], s[8:9]
    v_pk_mul_f32 v[132:133], v[208:209], s[8:9]
    v_pk_mul_f32 v[134:135], v[210:211], s[8:9]
    v_pk_mul_f32 v[136:137], v[196:197], s[8:9]
    v_pk_mul_f32 v[138:139], v[198:199], s[8:9]
    v_pk_mul_f32 v[140:141], v[204:205], s[8:9]
    v_pk_mul_f32 v[142:143], v[206:207], s[8:9]
    v_pk_mul_f32 v[144:145], v[212:213], s[8:9]
    v_pk_mul_f32 v[146:147], v[214:215], s[8:9]
    v_min_f32 v124, 0, v124
    v_min_f32 v125, 0, v125
    v_max_f32 v192, 0, v192
    v_max_f32 v193, 0, v193
    v_min_f32 v126, 0, v126
    v_min_f32 v127, 0, v127
    v_max_f32 v194, 0, v194
    v_max_f32 v195, 0, v195
    v_min_f32 v128, 0, v128
    v_min_f32 v129, 0, v129
    v_max_f32 v200, 0, v200
    v_max_f32 v201, 0, v201
    v_min_f32 v130, 0, v130
    v_min_f32 v131, 0, v131
    v_max_f32 v202, 0, v202
    v_max_f32 v203, 0, v203
    v_min_f32 v132, 0, v132
    v_min_f32 v133, 0, v133
    v_max_f32 v208, 0, v208
    v_max_f32 v209, 0, v209
    v_min_f32 v134, 0, v134
    v_min_f32 v135, 0, v135
    v_max_f32 v210, 0, v210
    v_max_f32 v211, 0, v211
    v_min_f32 v136, 0, v136
    v_min_f32 v137, 0, v137
    v_max_f32 v196, 0, v196
    v_max_f32 v197, 0, v197
    v_min_f32 v138, 0, v138
    v_min_f32 v139, 0, v139
    v_max_f32 v198, 0, v198
    v_max_f32 v199, 0, v199
    v_min_f32 v140, 0, v140
    v_min_f32 v141, 0, v141
    v_max_f32 v204, 0, v204
    v_max_f32 v205, 0, v205
    v_min_f32 v142, 0, v142
    v_min_f32 v143, 0, v143
    v_max_f32 v206, 0, v206
    v_max_f32 v207, 0, v207
    v_min_f32 v144, 0, v144
    v_min_f32 v145, 0, v145
    v_max_f32 v212, 0, v212
    v_max_f32 v213, 0, v213
    v_min_f32 v146, 0, v146
    v_min_f32 v147, 0, v147
    v_max_f32 v214, 0, v214
    v_max_f32 v215, 0, v215
    v_exp_f32 v124, v124
    v_exp_f32 v125, v125
    v_pk_add_f32 v[192:193], v[192:193], s[6:7]
    v_exp_f32 v126, v126
    v_exp_f32 v127, v127
    v_pk_add_f32 v[194:195], v[194:195], s[6:7]
    v_exp_f32 v128, v128
    v_exp_f32 v129, v129
    v_pk_add_f32 v[200:201], v[200:201], s[6:7]
    v_exp_f32 v130, v130
    v_exp_f32 v131, v131
    v_pk_add_f32 v[202:203], v[202:203], s[6:7]
    v_exp_f32 v132, v132
    v_exp_f32 v133, v133
    v_pk_add_f32 v[208:209], v[208:209], s[6:7]
    v_exp_f32 v134, v134
    v_exp_f32 v135, v135
    v_pk_add_f32 v[210:211], v[210:211], s[6:7]
    v_exp_f32 v136, v136
    v_exp_f32 v137, v137
    v_pk_add_f32 v[196:197], v[196:197], s[6:7]
    v_exp_f32 v138, v138
    v_exp_f32 v139, v139
    v_pk_add_f32 v[198:199], v[198:199], s[6:7]
    v_exp_f32 v140, v140
    v_exp_f32 v141, v141
    v_pk_add_f32 v[204:205], v[204:205], s[6:7]
    v_exp_f32 v142, v142
    v_exp_f32 v143, v143
    v_pk_add_f32 v[206:207], v[206:207], s[6:7]
    v_exp_f32 v144, v144
    v_exp_f32 v145, v145
    v_pk_add_f32 v[212:213], v[212:213], s[6:7]
    v_exp_f32 v146, v146
    v_exp_f32 v147, v147
    v_pk_add_f32 v[214:215], v[214:215], s[6:7]
    v_pk_add_f32 v[192:193], v[192:193], v[124:125]
    v_pk_add_f32 v[194:195], v[194:195], v[126:127]
    v_pk_add_f32 v[200:201], v[200:201], v[128:129]
    v_pk_add_f32 v[202:203], v[202:203], v[130:131]
    v_pk_add_f32 v[208:209], v[208:209], v[132:133]
    v_pk_add_f32 v[210:211], v[210:211], v[134:135]
    v_pk_add_f32 v[196:197], v[196:197], v[136:137]
    v_pk_add_f32 v[198:199], v[198:199], v[138:139]
    v_pk_add_f32 v[204:205], v[204:205], v[140:141]
    v_pk_add_f32 v[206:207], v[206:207], v[142:143]
    v_pk_add_f32 v[212:213], v[212:213], v[144:145]
    v_pk_add_f32 v[214:215], v[214:215], v[146:147]
    v_cvt_pk_bf16_f32 v0, v192, v193
    v_cvt_pk_bf16_f32 v1, v194, v195
    v_cvt_pk_bf16_f32 v4, v200, v201
    v_cvt_pk_bf16_f32 v5, v202, v203
    v_cvt_pk_bf16_f32 v2, v208, v209
    v_cvt_pk_bf16_f32 v3, v210, v211
    v_cvt_pk_bf16_f32 v8, v196, v197
    v_cvt_pk_bf16_f32 v9, v198, v199
    v_cvt_pk_bf16_f32 v12, v204, v205
    v_cvt_pk_bf16_f32 v13, v206, v207
    v_cvt_pk_bf16_f32 v10, v212, v213
    v_cvt_pk_bf16_f32 v11, v214, v215
    v_cmp_gt_u32 vcc, 2, v253
    s_nop 1
    v_cndmask_b32 v2, 0, v2, vcc
    v_mov_b32 v6, v2
    v_cndmask_b32 v3, 0, v3, vcc
    v_mov_b32 v7, v3
    v_cndmask_b32 v10, 0, v10, vcc
    v_mov_b32 v14, v10
    v_cndmask_b32 v11, 0, v11, vcc
    v_mov_b32 v15, v11
    v_mov_b32 v124, v23
    v_cmp_eq_u32 vcc, 0, v253
    s_nop 1
    v_cndmask_b32 v19, v19, v252, vcc
    v_mul_u32_u24 v125, 13108, v124
    v_lshrrev_b32 v125, 16, v125
    v_mul_u32_u24 v126, 5, v125
    v_sub_u32 v126, v124, v126
    v_lshlrev_b32 v127, 4, v126
    v_cmp_lt_u32 vcc, 20, v125
    s_nop 1
    v_cndmask_b32 v128, 8, 24, vcc
    v_cmp_eq_u32 vcc, 4, v126
    s_nop 1
    v_cndmask_b32 v127, v127, v128, vcc
    v_min_u32 v125, 42, v125
    v_lshl_add_u32 v18, v125, 6, v127
    v_add_u32 v18, 146432, v18
    v_lshlrev_b32 v22, 4, v253
    v_add_u32 v22, 146432, v22
    v_lshl_add_u32 v20, v254, 6, v22
    v_and_b32 v21, 3, v254
    v_lshl_add_u32 v21, v21, 6, v22
    s_setprio 3
    s_mul_i32 s4, s82, 160
    v_lshl_add_u32 v249, v253, 4, s4
    s_lshl_b32 s4, s81, 2
    s_add_u32 s4, s4, s79
    s_lshl_b32 s5, s4, 8
    s_add_u32 s5, s5, 15466504
    s_mul_i32 s16, s4, 20480
    v_lshlrev_b32 v248, 4, v254
    buffer_load_dwordx4 v[244:247], v249, s[52:55], 0 offen offset:64
    buffer_load_dword v248, v248, s[68:71], s5 offen sc1
    s_movk_i32 s4, 1280
    v_mad_u32_u24 v249, v254, s4, v249
    s_waitcnt vmcnt(3)
    v_mov_b32 v126, s22
    v_mov_b32 v127, 1
    ds_write_b32 v126, v127
    v_mov_b32 v126, 145420
    s_mov_b32 s5, 320000
L_sp7:
    ds_read_b32 v127, v126
    s_waitcnt lgkmcnt(0)
    v_cmp_gt_u32 vcc, 1, v127
    s_nop 4
    s_cbranch_vccz L_ok7
    s_sub_u32 s5, s5, 1
    s_cbranch_scc1 L_ok7
    s_sleep 1
    s_branch L_sp7
L_ok7:
    s_add_u32 s4, s14, 0
    buffer_load_dwordx4 v[128:131], v17, s[68:71], s4 offen sc1
    s_add_u32 s4, s14, 4096
    buffer_load_dwordx4 v[132:135], v17, s[68:71], s4 offen sc1
    s_add_u32 s4, s14, 8192
    buffer_load_dwordx4 v[136:139], v17, s[68:71], s4 offen sc1
    s_add_u32 s4, s14, 12288
    buffer_load_dwordx4 v[140:143], v17, s[68:71], s4 offen sc1
    s_add_u32 s4, s14, 16384
    buffer_load_dwordx4 v[144:147], v17, s[68:71], s4 offen sc1
    s_add_u32 s4, s14, 20480
    buffer_load_dwordx4 v[148:151], v17, s[68:71], s4 offen sc1
    s_add_u32 s4, s14, 24576
    buffer_load_dwordx4 v[152:155], v17, s[68:71], s4 offen sc1
    s_add_u32 s4, s14, 28672
    buffer_load_dwordx4 v[156:159], v17, s[68:71], s4 offen sc1
    s_add_u32 s4, s14, 32768
    buffer_load_dwordx4 v[160:163], v17, s[68:71], s4 offen sc1
    s_add_u32 s4, s14, 36864
    buffer_load_dwordx4 v[164:167], v17, s[68:71], s4 offen sc1
    s_add_u32 s4, s14, 40960
    buffer_load_dwordx4 v[168:171], v17, s[68:71], s4 offen sc1
    s_add_u32 s4, s14, 45056
    buffer_load_dwordx4 v[172:175], v17, s[68:71], s4 offen sc1
    s_add_u32 s4, s14, 49152
    buffer_load_dwordx4 v[176:179], v17, s[68:71], s4 offen sc1
    s_add_u32 s4, s14, 53248
    buffer_load_dwordx4 v[180:183], v17, s[68:71], s4 offen sc1
    s_add_u32 s4, s14, 57344
    buffer_load_dwordx4 v[184:187], v17, s[68:71], s4 offen sc1
    s_add_u32 s4, s14, 61440
    buffer_load_dwordx4 v[188:191], v17, s[68:71], s4 offen sc1
    s_mov_b32 s15, 20000
L_sp8:
    s_waitcnt vmcnt(0)
    v_pk_add_f32 v[196:197], v[128:129], v[136:137]
    v_pk_add_f32 v[198:199], v[130:131], v[138:139]
    v_pk_add_f32 v[200:201], v[132:133], v[140:141]
    v_pk_add_f32 v[202:203], v[134:135], v[142:143]
    v_pk_add_f32 v[196:197], v[144:145], v[196:197]
    v_pk_add_f32 v[198:199], v[146:147], v[198:199]
    v_pk_add_f32 v[200:201], v[148:149], v[200:201]
    v_pk_add_f32 v[202:203], v[150:151], v[202:203]
    v_pk_add_f32 v[196:197], v[152:153], v[196:197]
    v_pk_add_f32 v[198:199], v[154:155], v[198:199]
    v_pk_add_f32 v[200:201], v[156:157], v[200:201]
    v_pk_add_f32 v[202:203], v[158:159], v[202:203]
    v_pk_add_f32 v[196:197], v[160:161], v[196:197]
    v_pk_add_f32 v[198:199], v[162:163], v[198:199]
    v_pk_add_f32 v[200:201], v[164:165], v[200:201]
    v_pk_add_f32 v[202:203], v[166:167], v[202:203]
    v_pk_add_f32 v[196:197], v[168:169], v[196:197]
    v_pk_add_f32 v[198:199], v[170:171], v[198:199]
    v_pk_add_f32 v[200:201], v[172:173], v[200:201]
    v_pk_add_f32 v[202:203], v[174:175], v[202:203]
    v_pk_add_f32 v[196:197], v[176:177], v[196:197]
    v_pk_add_f32 v[198:199], v[178:179], v[198:199]
    v_pk_add_f32 v[200:201], v[180:181], v[200:201]
    v_pk_add_f32 v[202:203], v[182:183], v[202:203]
    v_pk_add_f32 v[196:197], v[184:185], v[196:197]
    v_pk_add_f32 v[198:199], v[186:187], v[198:199]
    v_pk_add_f32 v[200:201], v[188:189], v[200:201]
    v_pk_add_f32 v[202:203], v[190:191], v[202:203]
    v_pk_add_f32 v[196:197], v[196:197], v[200:201]
    v_pk_add_f32 v[198:199], v[198:199], v[202:203]
    v_cmp_u_f32 vcc, v196, v197
    v_cmp_u_f32 s[4:5], v198, v199
    s_nop 1
    s_or_b64 vcc, vcc, s[4:5]
    s_nop 4
    s_cbranch_vccz L_ok8
    s_sub_u32 s15, s15, 1
    s_cbranch_scc1 L_ok8
    s_sleep 8
    v_pk_add_f32 v[204:205], v[128:129], v[130:131]
    v_cmpx_u_f32 vcc, v204, v205
    s_nop 3
    s_add_u32 s4, s14, 0
    buffer_load_dwordx4 v[128:131], v17, s[68:71], s4 offen sc1
    s_mov_b64 exec, -1
    v_pk_add_f32 v[204:205], v[132:133], v[134:135]
    v_cmpx_u_f32 vcc, v204, v205
    s_nop 3
    s_add_u32 s4, s14, 4096
    buffer_load_dwordx4 v[132:135], v17, s[68:71], s4 offen sc1
    s_mov_b64 exec, -1
    v_pk_add_f32 v[204:205], v[136:137], v[138:139]
    v_cmpx_u_f32 vcc, v204, v205
    s_nop 3
    s_add_u32 s4, s14, 8192
    buffer_load_dwordx4 v[136:139], v17, s[68:71], s4 offen sc1
    s_mov_b64 exec, -1
    v_pk_add_f32 v[204:205], v[140:141], v[142:143]
    v_cmpx_u_f32 vcc, v204, v205
    s_nop 3
    s_add_u32 s4, s14, 12288
    buffer_load_dwordx4 v[140:143], v17, s[68:71], s4 offen sc1
    s_mov_b64 exec, -1
    v_pk_add_f32 v[204:205], v[144:145], v[146:147]
    v_cmpx_u_f32 vcc, v204, v205
    s_nop 3
    s_add_u32 s4, s14, 16384
    buffer_load_dwordx4 v[144:147], v17, s[68:71], s4 offen sc1
    s_mov_b64 exec, -1
    v_pk_add_f32 v[204:205], v[148:149], v[150:151]
    v_cmpx_u_f32 vcc, v204, v205
    s_nop 3
    s_add_u32 s4, s14, 20480
    buffer_load_dwordx4 v[148:151], v17, s[68:71], s4 offen sc1
    s_mov_b64 exec, -1
    v_pk_add_f32 v[204:205], v[152:153], v[154:155]
    v_cmpx_u_f32 vcc, v204, v205
    s_nop 3
    s_add_u32 s4, s14, 24576
    buffer_load_dwordx4 v[152:155], v17, s[68:71], s4 offen sc1
    s_mov_b64 exec, -1
    v_pk_add_f32 v[204:205], v[156:157], v[158:159]
    v_cmpx_u_f32 vcc, v204, v205
    s_nop 3
    s_add_u32 s4, s14, 28672
    buffer_load_dwordx4 v[156:159], v17, s[68:71], s4 offen sc1
    s_mov_b64 exec, -1
    v_pk_add_f32 v[204:205], v[160:161], v[162:163]
    v_cmpx_u_f32 vcc, v204, v205
    s_nop 3
    s_add_u32 s4, s14, 32768
    buffer_load_dwordx4 v[160:163], v17, s[68:71], s4 offen sc1
    s_mov_b64 exec, -1
    v_pk_add_f32 v[204:205], v[164:165], v[166:167]
    v_cmpx_u_f32 vcc, v204, v205
    s_nop 3
    s_add_u32 s4, s14, 36864
    buffer_load_dwordx4 v[164:167], v17, s[68:71], s4 offen sc1
    s_mov_b64 exec, -1
    v_pk_add_f32 v[204:205], v[168:169], v[170:171]
    v_cmpx_u_f32 vcc, v204, v205
    s_nop 3
    s_add_u32 s4, s14, 40960
    buffer_load_dwordx4 v[168:171], v17, s[68:71], s4 offen sc1
    s_mov_b64 exec, -1
    v_pk_add_f32 v[204:205], v[172:173], v[174:175]
    v_cmpx_u_f32 vcc, v204, v205
    s_nop 3
    s_add_u32 s4, s14, 45056
    buffer_load_dwordx4 v[172:175], v17, s[68:71], s4 offen sc1
    s_mov_b64 exec, -1
    v_pk_add_f32 v[204:205], v[176:177], v[178:179]
    v_cmpx_u_f32 vcc, v204, v205
    s_nop 3
    s_add_u32 s4, s14, 49152
    buffer_load_dwordx4 v[176:179], v17, s[68:71], s4 offen sc1
    s_mov_b64 exec, -1
    v_pk_add_f32 v[204:205], v[180:181], v[182:183]
    v_cmpx_u_f32 vcc, v204, v205
    s_nop 3
    s_add_u32 s4, s14, 53248
    buffer_load_dwordx4 v[180:183], v17, s[68:71], s4 offen sc1
    s_mov_b64 exec, -1
    v_pk_add_f32 v[204:205], v[184:185], v[186:187]
    v_cmpx_u_f32 vcc, v204, v205
    s_nop 3
    s_add_u32 s4, s14, 57344
    buffer_load_dwordx4 v[184:187], v17, s[68:71], s4 offen sc1
    s_mov_b64 exec, -1
    v_pk_add_f32 v[204:205], v[188:189], v[190:191]
    v_cmpx_u_f32 vcc, v204, v205
    s_nop 3
    s_add_u32 s4, s14, 61440
    buffer_load_dwordx4 v[188:191], v17, s[68:71], s4 offen sc1
    s_mov_b64 exec, -1
    s_branch L_sp8
L_ok8:
    v_cvt_pk_bf16_f32 v196, v196, v197
    v_cvt_pk_bf16_f32 v197, v198, v199
    ds_write_b64 v18, v[196:197]
    v_mov_b32 v16, 145408
    v_mov_b32 v17, 1
    s_mov_b64 exec, 1
    ds_add_u32 v16, v17
    s_mov_b64 exec, -1
    v_mov_b32 v16, 145408
    s_mov_b32 s5, 320000
L_sp9:
    ds_read_b32 v17, v16
    s_waitcnt lgkmcnt(0)
    v_and_b32 v17, 15, v17
    v_cmp_gt_u32 vcc, 4, v17
    s_nop 4
    s_cbranch_vccz L_ok9
    s_sub_u32 s5, s5, 1
    s_cbranch_scc1 L_ok9
    s_sleep 1
    s_branch L_sp9
L_ok9:
    ds_read_b128 v[124:127], v20 offset:0
    ds_read_b128 v[128:131], v21 offset:1024
    ds_read_b128 v[132:135], v22 offset:1280
    ds_read_b128 v[136:139], v20 offset:1344
    ds_read_b128 v[140:143], v21 offset:2368
    ds_read_b128 v[144:147], v22 offset:2624
    s_waitcnt lgkmcnt(0)
    v_mfma_f32_16x16x32_bf16 v[148:151], v[124:127], v[0:3], 0
    v_mfma_f32_16x16x32_bf16 v[152:155], v[128:131], v[0:3], 0
    v_mfma_f32_16x16x32_bf16 v[156:159], v[132:135], v[0:3], 0
    v_mfma_f32_16x16x32_bf16 v[160:163], v[136:139], v[4:7], 0
    v_mfma_f32_16x16x32_bf16 v[164:167], v[140:143], v[4:7], 0
    v_mfma_f32_16x16x32_bf16 v[168:171], v[144:147], v[4:7], 0
    v_mfma_f32_16x16x32_bf16 v[172:175], v[124:127], v[8:11], 0
    v_mfma_f32_16x16x32_bf16 v[176:179], v[128:131], v[8:11], 0
    v_mfma_f32_16x16x32_bf16 v[180:183], v[132:135], v[8:11], 0
    v_mfma_f32_16x16x32_bf16 v[184:187], v[136:139], v[12:15], 0
    v_mfma_f32_16x16x32_bf16 v[188:191], v[140:143], v[12:15], 0
    v_mfma_f32_16x16x32_bf16 v[192:195], v[144:147], v[12:15], 0
    v_add_f32 v156, s6, v156
    v_rcp_f32 v156, v156
    s_nop 0
    v_mul_f32 v156, v156, v238
    v_pk_mul_f32 v[148:149], v[148:149], v[156:157] op_sel_hi:[1,0]
    v_pk_mul_f32 v[150:151], v[150:151], v[156:157] op_sel_hi:[1,0]
    v_pk_mul_f32 v[152:153], v[152:153], v[156:157] op_sel_hi:[1,0]
    v_pk_mul_f32 v[154:155], v[154:155], v[156:157] op_sel_hi:[1,0]
    v_cvt_pk_bf16_f32 v204, v148, v149
    v_cvt_pk_bf16_f32 v205, v150, v151
    v_cvt_pk_bf16_f32 v208, v152, v153
    v_cvt_pk_bf16_f32 v209, v154, v155
    v_add_f32 v168, s6, v168
    v_rcp_f32 v168, v168
    s_nop 0
    v_mul_f32 v168, v168, v238
    v_pk_mul_f32 v[160:161], v[160:161], v[168:169] op_sel_hi:[1,0]
    v_pk_mul_f32 v[162:163], v[162:163], v[168:169] op_sel_hi:[1,0]
    v_pk_mul_f32 v[164:165], v[164:165], v[168:169] op_sel_hi:[1,0]
    v_pk_mul_f32 v[166:167], v[166:167], v[168:169] op_sel_hi:[1,0]
    v_cvt_pk_bf16_f32 v206, v160, v161
    v_cvt_pk_bf16_f32 v207, v162, v163
    v_cvt_pk_bf16_f32 v210, v164, v165
    v_cvt_pk_bf16_f32 v211, v166, v167
    s_add_u32 s4, s18, 0
    s_add_u32 s5, s19, 0
    buffer_store_dwordx4 v[204:207], v252, s[68:71], s4 offen sc1
    buffer_store_dwordx4 v[208:211], v19, s[68:71], s5 offen sc1
    v_add_f32 v180, s6, v180
    v_rcp_f32 v180, v180
    s_nop 0
    v_mul_f32 v180, v180, v242
    v_pk_mul_f32 v[172:173], v[172:173], v[180:181] op_sel_hi:[1,0]
    v_pk_mul_f32 v[174:175], v[174:175], v[180:181] op_sel_hi:[1,0]
    v_pk_mul_f32 v[176:177], v[176:177], v[180:181] op_sel_hi:[1,0]
    v_pk_mul_f32 v[178:179], v[178:179], v[180:181] op_sel_hi:[1,0]
    v_cvt_pk_bf16_f32 v212, v172, v173
    v_cvt_pk_bf16_f32 v213, v174, v175
    v_cvt_pk_bf16_f32 v216, v176, v177
    v_cvt_pk_bf16_f32 v217, v178, v179
    v_add_f32 v192, s6, v192
    v_rcp_f32 v192, v192
    s_nop 0
    v_mul_f32 v192, v192, v242
    v_pk_mul_f32 v[184:185], v[184:185], v[192:193] op_sel_hi:[1,0]
    v_pk_mul_f32 v[186:187], v[186:187], v[192:193] op_sel_hi:[1,0]
    v_pk_mul_f32 v[188:189], v[188:189], v[192:193] op_sel_hi:[1,0]
    v_pk_mul_f32 v[190:191], v[190:191], v[192:193] op_sel_hi:[1,0]
    v_cvt_pk_bf16_f32 v214, v184, v185
    v_cvt_pk_bf16_f32 v215, v186, v187
    v_cvt_pk_bf16_f32 v218, v188, v189
    v_cvt_pk_bf16_f32 v219, v190, v191
    s_add_u32 s4, s18, 75776
    s_add_u32 s5, s19, 75776
    buffer_store_dwordx4 v[212:215], v252, s[68:71], s4 offen sc1
    buffer_store_dwordx4 v[216:219], v19, s[68:71], s5 offen sc1
    v_mov_b32 v16, 145408
    s_mov_b32 s5, 320000
L_sp10:
    ds_read_b32 v17, v16
    s_waitcnt lgkmcnt(0)
    v_cmp_gt_u32 vcc, 68, v17
    s_nop 4
    s_cbranch_vccz L_ok10
    s_sub_u32 s5, s5, 1
    s_cbranch_scc1 L_ok10
    s_sleep 1
    s_branch L_sp10
L_ok10:
    s_add_u32 s4, s13, 55296
    buffer_load_dwordx4 v[124:127], v252, s[68:71], s4 offen sc1
    s_add_u32 s4, s13, 59392
    buffer_load_dwordx4 v[128:131], v252, s[68:71], s4 offen sc1
    s_add_u32 s4, s13, 63488
    buffer_load_dwordx4 v[132:135], v252, s[68:71], s4 offen sc1
    s_add_u32 s4, s13, 67584
    buffer_load_dwordx4 v[136:139], v252, s[68:71], s4 offen sc1
    s_add_u32 s4, s13, 71680
    buffer_load_dwordx4 v[140:143], v252, s[68:71], s4 offen sc1
    s_add_u32 s4, s13, 131072
    buffer_load_dwordx4 v[144:147], v252, s[68:71], s4 offen sc1
    s_add_u32 s4, s13, 135168
    buffer_load_dwordx4 v[148:151], v252, s[68:71], s4 offen sc1
    s_add_u32 s4, s13, 139264
    buffer_load_dwordx4 v[152:155], v252, s[68:71], s4 offen sc1
    s_add_u32 s4, s13, 143360
    buffer_load_dwordx4 v[156:159], v252, s[68:71], s4 offen sc1
    s_add_u32 s4, s13, 147456
    buffer_load_dwordx4 v[160:163], v252, s[68:71], s4 offen sc1
    s_setprio 3
    s_sub_u32 s4, s86, 1024
    v_add_u32 v20, s4, v252
    s_sub_u32 s6, s86, 1024
    s_mov_b32 s15, 20000
    s_waitcnt vmcnt(5)
L_sp11:
    v_max_u32 v22, v124, v125
    v_max3_u32 v22, v22, v126, v127
    v_max3_u32 v22, v22, v128, v129
    v_max3_u32 v22, v22, v130, v131
    v_max3_u32 v22, v22, v132, v133
    v_max3_u32 v22, v22, v134, v135
    v_max3_u32 v22, v22, v136, v137
    v_max3_u32 v22, v22, v138, v139
    v_max3_u32 v22, v22, v140, v141
    v_max3_u32 v22, v22, v142, v143
    v_cmp_eq_u32 vcc, -1, v22
    s_nop 4
    s_cbranch_vccz L_ok11
    s_sub_u32 s15, s15, 1
    s_cbranch_scc1 L_ok11
    s_sleep 8
    v_max3_u32 v23, v124, v125, v126
    v_max_u32 v23, v23, v127
    v_cmpx_eq_u32 vcc, -1, v23
    s_nop 3
    s_add_u32 s4, s13, 55296
    buffer_load_dwordx4 v[124:127], v252, s[68:71], s4 offen sc1
    s_mov_b64 exec, -1
    v_max3_u32 v23, v128, v129, v130
    v_max_u32 v23, v23, v131
    v_cmpx_eq_u32 vcc, -1, v23
    s_nop 3
    s_add_u32 s4, s13, 59392
    buffer_load_dwordx4 v[128:131], v252, s[68:71], s4 offen sc1
    s_mov_b64 exec, -1
    v_max3_u32 v23, v132, v133, v134
    v_max_u32 v23, v23, v135
    v_cmpx_eq_u32 vcc, -1, v23
    s_nop 3
    s_add_u32 s4, s13, 63488
    buffer_load_dwordx4 v[132:135], v252, s[68:71], s4 offen sc1
    s_mov_b64 exec, -1
    v_max3_u32 v23, v136, v137, v138
    v_max_u32 v23, v23, v139
    v_cmpx_eq_u32 vcc, -1, v23
    s_nop 3
    s_add_u32 s4, s13, 67584
    buffer_load_dwordx4 v[136:139], v252, s[68:71], s4 offen sc1
    s_mov_b64 exec, -1
    v_max3_u32 v23, v140, v141, v142
    v_max_u32 v23, v23, v143
    v_cmpx_eq_u32 vcc, -1, v23
    s_nop 3
    s_add_u32 s4, s13, 71680
    buffer_load_dwordx4 v[140:143], v252, s[68:71], s4 offen sc1
    s_mov_b64 exec, -1
    s_waitcnt vmcnt(0)
    s_branch L_sp11
L_ok11:
    v_mfma_f32_16x16x32_bf16 v[0:3], v[24:27], v[124:127], 0
    v_mfma_f32_16x16x32_bf16 v[4:7], v[28:31], v[124:127], 0
    v_mfma_f32_16x16x32_bf16 v[8:11], v[32:35], v[124:127], 0
    v_mfma_f32_16x16x32_bf16 v[12:15], v[36:39], v[124:127], 0
    v_mfma_f32_16x16x32_bf16 v[16:19], v[40:43], v[124:127], 0
    s_add_u32 s4, s13, 206848
    buffer_load_dwordx4 v[164:167], v252, s[68:71], s4 offen sc1
    v_mfma_f32_16x16x32_bf16 v[0:3], v[44:47], v[128:131], v[0:3]
    v_mfma_f32_16x16x32_bf16 v[4:7], v[48:51], v[128:131], v[4:7]
    v_mfma_f32_16x16x32_bf16 v[8:11], v[52:55], v[128:131], v[8:11]
    v_mfma_f32_16x16x32_bf16 v[12:15], v[56:59], v[128:131], v[12:15]
    v_mfma_f32_16x16x32_bf16 v[16:19], v[60:63], v[128:131], v[16:19]
    s_add_u32 s4, s13, 210944
    buffer_load_dwordx4 v[168:171], v252, s[68:71], s4 offen sc1
    v_mfma_f32_16x16x32_bf16 v[0:3], v[64:67], v[132:135], v[0:3]
    v_mfma_f32_16x16x32_bf16 v[4:7], v[68:71], v[132:135], v[4:7]
    v_mfma_f32_16x16x32_bf16 v[8:11], v[72:75], v[132:135], v[8:11]
    v_mfma_f32_16x16x32_bf16 v[12:15], v[76:79], v[132:135], v[12:15]
    v_mfma_f32_16x16x32_bf16 v[16:19], v[80:83], v[132:135], v[16:19]
    s_add_u32 s4, s13, 215040
    buffer_load_dwordx4 v[172:175], v252, s[68:71], s4 offen sc1
    v_mfma_f32_16x16x32_bf16 v[0:3], v[84:87], v[136:139], v[0:3]
    v_mfma_f32_16x16x32_bf16 v[4:7], v[88:91], v[136:139], v[4:7]
    v_mfma_f32_16x16x32_bf16 v[8:11], v[92:95], v[136:139], v[8:11]
    v_mfma_f32_16x16x32_bf16 v[12:15], v[96:99], v[136:139], v[12:15]
    v_mfma_f32_16x16x32_bf16 v[16:19], v[100:103], v[136:139], v[16:19]
    s_add_u32 s4, s13, 219136
    buffer_load_dwordx4 v[176:179], v252, s[68:71], s4 offen sc1
    v_mfma_f32_16x16x32_bf16 v[0:3], v[104:107], v[140:143], v[0:3]
    v_mfma_f32_16x16x32_bf16 v[4:7], v[108:111], v[140:143], v[4:7]
    v_mfma_f32_16x16x32_bf16 v[8:11], v[112:115], v[140:143], v[8:11]
    v_mfma_f32_16x16x32_bf16 v[12:15], v[116:119], v[140:143], v[12:15]
    v_mfma_f32_16x16x32_bf16 v[16:19], v[120:123], v[140:143], v[16:19]
    s_add_u32 s4, s13, 223232
    buffer_load_dwordx4 v[180:183], v252, s[68:71], s4 offen sc1
    s_mov_b32 s15, 20000
    s_waitcnt vmcnt(5)
L_sp12:
    v_max_u32 v22, v144, v145
    v_max3_u32 v22, v22, v146, v147
    v_max3_u32 v22, v22, v148, v149
    v_max3_u32 v22, v22, v150, v151
    v_max3_u32 v22, v22, v152, v153
    v_max3_u32 v22, v22, v154, v155
    v_max3_u32 v22, v22, v156, v157
    v_max3_u32 v22, v22, v158, v159
    v_max3_u32 v22, v22, v160, v161
    v_max3_u32 v22, v22, v162, v163
    v_cmp_eq_u32 vcc, -1, v22
    s_nop 4
    s_cbranch_vccz L_ok12
    s_sub_u32 s15, s15, 1
    s_cbranch_scc1 L_ok12
    s_sleep 8
    v_max3_u32 v23, v144, v145, v146
    v_max_u32 v23, v23, v147
    v_cmpx_eq_u32 vcc, -1, v23
    s_nop 3
    s_add_u32 s4, s13, 131072
    buffer_load_dwordx4 v[144:147], v252, s[68:71], s4 offen sc1
    s_mov_b64 exec, -1
    v_max3_u32 v23, v148, v149, v150
    v_max_u32 v23, v23, v151
    v_cmpx_eq_u32 vcc, -1, v23
    s_nop 3
    s_add_u32 s4, s13, 135168
    buffer_load_dwordx4 v[148:151], v252, s[68:71], s4 offen sc1
    s_mov_b64 exec, -1
    v_max3_u32 v23, v152, v153, v154
    v_max_u32 v23, v23, v155
    v_cmpx_eq_u32 vcc, -1, v23
    s_nop 3
    s_add_u32 s4, s13, 139264
    buffer_load_dwordx4 v[152:155], v252, s[68:71], s4 offen sc1
    s_mov_b64 exec, -1
    v_max3_u32 v23, v156, v157, v158
    v_max_u32 v23, v23, v159
    v_cmpx_eq_u32 vcc, -1, v23
    s_nop 3
    s_add_u32 s4, s13, 143360
    buffer_load_dwordx4 v[156:159], v252, s[68:71], s4 offen sc1
    s_mov_b64 exec, -1
    v_max3_u32 v23, v160, v161, v162
    v_max_u32 v23, v23, v163
    v_cmpx_eq_u32 vcc, -1, v23
    s_nop 3
    s_add_u32 s4, s13, 147456
    buffer_load_dwordx4 v[160:163], v252, s[68:71], s4 offen sc1
    s_mov_b64 exec, -1
    s_waitcnt vmcnt(0)
    s_branch L_sp12
L_ok12:
    v_mfma_f32_16x16x32_bf16 v[204:207], v[24:27], v[144:147], 0
    v_mfma_f32_16x16x32_bf16 v[208:211], v[28:31], v[144:147], 0
    v_mfma_f32_16x16x32_bf16 v[212:215], v[32:35], v[144:147], 0
    v_mfma_f32_16x16x32_bf16 v[216:219], v[36:39], v[144:147], 0
    v_mfma_f32_16x16x32_bf16 v[220:223], v[40:43], v[144:147], 0
    s_add_u32 s4, s13, 282624
    buffer_load_dwordx4 v[184:187], v252, s[68:71], s4 offen sc1
    v_mfma_f32_16x16x32_bf16 v[204:207], v[44:47], v[148:151], v[204:207]
    v_mfma_f32_16x16x32_bf16 v[208:211], v[48:51], v[148:151], v[208:211]
    v_mfma_f32_16x16x32_bf16 v[212:215], v[52:55], v[148:151], v[212:215]
    v_mfma_f32_16x16x32_bf16 v[216:219], v[56:59], v[148:151], v[216:219]
    v_mfma_f32_16x16x32_bf16 v[220:223], v[60:63], v[148:151], v[220:223]
    s_add_u32 s4, s13, 286720
    buffer_load_dwordx4 v[188:191], v252, s[68:71], s4 offen sc1
    v_mfma_f32_16x16x32_bf16 v[204:207], v[64:67], v[152:155], v[204:207]
    v_mfma_f32_16x16x32_bf16 v[208:211], v[68:71], v[152:155], v[208:211]
    v_mfma_f32_16x16x32_bf16 v[212:215], v[72:75], v[152:155], v[212:215]
    v_mfma_f32_16x16x32_bf16 v[216:219], v[76:79], v[152:155], v[216:219]
    v_mfma_f32_16x16x32_bf16 v[220:223], v[80:83], v[152:155], v[220:223]
    s_add_u32 s4, s13, 290816
    buffer_load_dwordx4 v[192:195], v252, s[68:71], s4 offen sc1
    v_mfma_f32_16x16x32_bf16 v[204:207], v[84:87], v[156:159], v[204:207]
    v_mfma_f32_16x16x32_bf16 v[208:211], v[88:91], v[156:159], v[208:211]
    v_mfma_f32_16x16x32_bf16 v[212:215], v[92:95], v[156:159], v[212:215]
    v_mfma_f32_16x16x32_bf16 v[216:219], v[96:99], v[156:159], v[216:219]
    v_mfma_f32_16x16x32_bf16 v[220:223], v[100:103], v[156:159], v[220:223]
    s_add_u32 s4, s13, 294912
    buffer_load_dwordx4 v[196:199], v252, s[68:71], s4 offen sc1
    v_mfma_f32_16x16x32_bf16 v[204:207], v[104:107], v[160:163], v[204:207]
    v_mfma_f32_16x16x32_bf16 v[208:211], v[108:111], v[160:163], v[208:211]
    v_mfma_f32_16x16x32_bf16 v[212:215], v[112:115], v[160:163], v[212:215]
    v_mfma_f32_16x16x32_bf16 v[216:219], v[116:119], v[160:163], v[216:219]
    v_mfma_f32_16x16x32_bf16 v[220:223], v[120:123], v[160:163], v[220:223]
    s_add_u32 s4, s13, 299008
    buffer_load_dwordx4 v[200:203], v252, s[68:71], s4 offen sc1
    ds_write_b128 v20, v[0:3] offset:0
    ds_write_b128 v20, v[4:7] offset:7168
    ds_write_b128 v20, v[16:19] offset:28672
    s_cmp_gt_u32 s79, 0
    s_cselect_b32 s4, s6, s86
    s_add_u32 s4, s4, 0
    v_add_u32 v21, s4, v252
    v_add_u32 v20, 35840, v20
    s_cmp_eq_u32 s79, 0
    s_cbranch_scc1 L_own10
    ds_write_b128 v21, v[8:11] offset:14336
    ds_write_b128 v21, v[12:15] offset:21504
    s_branch L_nown10
L_own10:
    v_mov_b32 v144, v8
    v_mov_b32 v145, v9
    v_mov_b32 v146, v10
    v_mov_b32 v147, v11
    v_mov_b32 v148, v12
    v_mov_b32 v149, v13
    v_mov_b32 v150, v14
    v_mov_b32 v151, v15
L_nown10:
    s_mov_b32 s15, 20000
    s_waitcnt vmcnt(5)
L_sp13:
    v_max_u32 v22, v164, v165
    v_max3_u32 v22, v22, v166, v167
    v_max3_u32 v22, v22, v168, v169
    v_max3_u32 v22, v22, v170, v171
    v_max3_u32 v22, v22, v172, v173
    v_max3_u32 v22, v22, v174, v175
    v_max3_u32 v22, v22, v176, v177
    v_max3_u32 v22, v22, v178, v179
    v_max3_u32 v22, v22, v180, v181
    v_max3_u32 v22, v22, v182, v183
    v_cmp_eq_u32 vcc, -1, v22
    s_nop 4
    s_cbranch_vccz L_ok13
    s_sub_u32 s15, s15, 1
    s_cbranch_scc1 L_ok13
    s_sleep 8
    v_max3_u32 v23, v164, v165, v166
    v_max_u32 v23, v23, v167
    v_cmpx_eq_u32 vcc, -1, v23
    s_nop 3
    s_add_u32 s4, s13, 206848
    buffer_load_dwordx4 v[164:167], v252, s[68:71], s4 offen sc1
    s_mov_b64 exec, -1
    v_max3_u32 v23, v168, v169, v170
    v_max_u32 v23, v23, v171
    v_cmpx_eq_u32 vcc, -1, v23
    s_nop 3
    s_add_u32 s4, s13, 210944
    buffer_load_dwordx4 v[168:171], v252, s[68:71], s4 offen sc1
    s_mov_b64 exec, -1
    v_max3_u32 v23, v172, v173, v174
    v_max_u32 v23, v23, v175
    v_cmpx_eq_u32 vcc, -1, v23
    s_nop 3
    s_add_u32 s4, s13, 215040
    buffer_load_dwordx4 v[172:175], v252, s[68:71], s4 offen sc1
    s_mov_b64 exec, -1
    v_max3_u32 v23, v176, v177, v178
    v_max_u32 v23, v23, v179
    v_cmpx_eq_u32 vcc, -1, v23
    s_nop 3
    s_add_u32 s4, s13, 219136
    buffer_load_dwordx4 v[176:179], v252, s[68:71], s4 offen sc1
    s_mov_b64 exec, -1
    v_max3_u32 v23, v180, v181, v182
    v_max_u32 v23, v23, v183
    v_cmpx_eq_u32 vcc, -1, v23
    s_nop 3
    s_add_u32 s4, s13, 223232
    buffer_load_dwordx4 v[180:183], v252, s[68:71], s4 offen sc1
    s_mov_b64 exec, -1
    s_waitcnt vmcnt(0)
    s_branch L_sp13
L_ok13:
    v_mfma_f32_16x16x32_bf16 v[224:227], v[24:27], v[164:167], 0
    v_mfma_f32_16x16x32_bf16 v[228:231], v[28:31], v[164:167], 0
    v_mfma_f32_16x16x32_bf16 v[232:235], v[32:35], v[164:167], 0
    v_mfma_f32_16x16x32_bf16 v[236:239], v[36:39], v[164:167], 0
    v_mfma_f32_16x16x32_bf16 v[240:243], v[40:43], v[164:167], 0
    v_mfma_f32_16x16x32_bf16 v[224:227], v[44:47], v[168:171], v[224:227]
    v_mfma_f32_16x16x32_bf16 v[228:231], v[48:51], v[168:171], v[228:231]
    v_mfma_f32_16x16x32_bf16 v[232:235], v[52:55], v[168:171], v[232:235]
    v_mfma_f32_16x16x32_bf16 v[236:239], v[56:59], v[168:171], v[236:239]
    v_mfma_f32_16x16x32_bf16 v[240:243], v[60:63], v[168:171], v[240:243]
    v_mfma_f32_16x16x32_bf16 v[224:227], v[64:67], v[172:175], v[224:227]
    v_mfma_f32_16x16x32_bf16 v[228:231], v[68:71], v[172:175], v[228:231]
    v_mfma_f32_16x16x32_bf16 v[232:235], v[72:75], v[172:175], v[232:235]
    v_mfma_f32_16x16x32_bf16 v[236:239], v[76:79], v[172:175], v[236:239]
    v_mfma_f32_16x16x32_bf16 v[240:243], v[80:83], v[172:175], v[240:243]
    v_mfma_f32_16x16x32_bf16 v[224:227], v[84:87], v[176:179], v[224:227]
    v_mfma_f32_16x16x32_bf16 v[228:231], v[88:91], v[176:179], v[228:231]
    v_mfma_f32_16x16x32_bf16 v[232:235], v[92:95], v[176:179], v[232:235]
    v_mfma_f32_16x16x32_bf16 v[236:239], v[96:99], v[176:179], v[236:239]
    v_mfma_f32_16x16x32_bf16 v[240:243], v[100:103], v[176:179], v[240:243]
    v_mfma_f32_16x16x32_bf16 v[224:227], v[104:107], v[180:183], v[224:227]
    v_mfma_f32_16x16x32_bf16 v[228:231], v[108:111], v[180:183], v[228:231]
    v_mfma_f32_16x16x32_bf16 v[232:235], v[112:115], v[180:183], v[232:235]
    v_mfma_f32_16x16x32_bf16 v[236:239], v[116:119], v[180:183], v[236:239]
    v_mfma_f32_16x16x32_bf16 v[240:243], v[120:123], v[180:183], v[240:243]
    ds_write_b128 v20, v[204:207] offset:0
    ds_write_b128 v20, v[208:211] offset:7168
    ds_write_b128 v20, v[220:223] offset:28672
    s_cmp_gt_u32 s79, 1
    s_cselect_b32 s4, s6, s86
    s_add_u32 s4, s4, 35840
    v_add_u32 v21, s4, v252
    v_add_u32 v20, 35840, v20
    s_cmp_eq_u32 s79, 1
    s_cbranch_scc1 L_own11
    ds_write_b128 v21, v[212:215] offset:14336
    ds_write_b128 v21, v[216:219] offset:21504
    s_branch L_nown11
L_own11:
    v_mov_b32 v144, v212
    v_mov_b32 v145, v213
    v_mov_b32 v146, v214
    v_mov_b32 v147, v215
    v_mov_b32 v148, v216
    v_mov_b32 v149, v217
    v_mov_b32 v150, v218
    v_mov_b32 v151, v219
L_nown11:
    s_mov_b32 s15, 20000
    s_waitcnt vmcnt(0)
L_sp14:
    v_max_u32 v22, v184, v185
    v_max3_u32 v22, v22, v186, v187
    v_max3_u32 v22, v22, v188, v189
    v_max3_u32 v22, v22, v190, v191
    v_max3_u32 v22, v22, v192, v193
    v_max3_u32 v22, v22, v194, v195
    v_max3_u32 v22, v22, v196, v197
    v_max3_u32 v22, v22, v198, v199
    v_max3_u32 v22, v22, v200, v201
    v_max3_u32 v22, v22, v202, v203
    v_cmp_eq_u32 vcc, -1, v22
    s_nop 4
    s_cbranch_vccz L_ok14
    s_sub_u32 s15, s15, 1
    s_cbranch_scc1 L_ok14
    s_sleep 8
    v_max3_u32 v23, v184, v185, v186
    v_max_u32 v23, v23, v187
    v_cmpx_eq_u32 vcc, -1, v23
    s_nop 3
    s_add_u32 s4, s13, 282624
    buffer_load_dwordx4 v[184:187], v252, s[68:71], s4 offen sc1
    s_mov_b64 exec, -1
    v_max3_u32 v23, v188, v189, v190
    v_max_u32 v23, v23, v191
    v_cmpx_eq_u32 vcc, -1, v23
    s_nop 3
    s_add_u32 s4, s13, 286720
    buffer_load_dwordx4 v[188:191], v252, s[68:71], s4 offen sc1
    s_mov_b64 exec, -1
    v_max3_u32 v23, v192, v193, v194
    v_max_u32 v23, v23, v195
    v_cmpx_eq_u32 vcc, -1, v23
    s_nop 3
    s_add_u32 s4, s13, 290816
    buffer_load_dwordx4 v[192:195], v252, s[68:71], s4 offen sc1
    s_mov_b64 exec, -1
    v_max3_u32 v23, v196, v197, v198
    v_max_u32 v23, v23, v199
    v_cmpx_eq_u32 vcc, -1, v23
    s_nop 3
    s_add_u32 s4, s13, 294912
    buffer_load_dwordx4 v[196:199], v252, s[68:71], s4 offen sc1
    s_mov_b64 exec, -1
    v_max3_u32 v23, v200, v201, v202
    v_max_u32 v23, v23, v203
    v_cmpx_eq_u32 vcc, -1, v23
    s_nop 3
    s_add_u32 s4, s13, 299008
    buffer_load_dwordx4 v[200:203], v252, s[68:71], s4 offen sc1
    s_mov_b64 exec, -1
    s_waitcnt vmcnt(0)
    s_branch L_sp14
L_ok14:
    v_mfma_f32_16x16x32_bf16 v[124:127], v[24:27], v[184:187], 0
    v_mfma_f32_16x16x32_bf16 v[128:131], v[28:31], v[184:187], 0
    v_mfma_f32_16x16x32_bf16 v[132:135], v[32:35], v[184:187], 0
    v_mfma_f32_16x16x32_bf16 v[136:139], v[36:39], v[184:187], 0
    v_mfma_f32_16x16x32_bf16 v[140:143], v[40:43], v[184:187], 0
    v_mfma_f32_16x16x32_bf16 v[124:127], v[44:47], v[188:191], v[124:127]
    v_mfma_f32_16x16x32_bf16 v[128:131], v[48:51], v[188:191], v[128:131]
    v_mfma_f32_16x16x32_bf16 v[132:135], v[52:55], v[188:191], v[132:135]
    v_mfma_f32_16x16x32_bf16 v[136:139], v[56:59], v[188:191], v[136:139]
    v_mfma_f32_16x16x32_bf16 v[140:143], v[60:63], v[188:191], v[140:143]
    v_mfma_f32_16x16x32_bf16 v[124:127], v[64:67], v[192:195], v[124:127]
    v_mfma_f32_16x16x32_bf16 v[128:131], v[68:71], v[192:195], v[128:131]
    v_mfma_f32_16x16x32_bf16 v[132:135], v[72:75], v[192:195], v[132:135]
    v_mfma_f32_16x16x32_bf16 v[136:139], v[76:79], v[192:195], v[136:139]
    v_mfma_f32_16x16x32_bf16 v[140:143], v[80:83], v[192:195], v[140:143]
    v_mfma_f32_16x16x32_bf16 v[124:127], v[84:87], v[196:199], v[124:127]
    v_mfma_f32_16x16x32_bf16 v[128:131], v[88:91], v[196:199], v[128:131]
    v_mfma_f32_16x16x32_bf16 v[132:135], v[92:95], v[196:199], v[132:135]
    v_mfma_f32_16x16x32_bf16 v[136:139], v[96:99], v[196:199], v[136:139]
    v_mfma_f32_16x16x32_bf16 v[140:143], v[100:103], v[196:199], v[140:143]
    v_mfma_f32_16x16x32_bf16 v[124:127], v[104:107], v[200:203], v[124:127]
    v_mfma_f32_16x16x32_bf16 v[128:131], v[108:111], v[200:203], v[128:131]
    v_mfma_f32_16x16x32_bf16 v[132:135], v[112:115], v[200:203], v[132:135]
    v_mfma_f32_16x16x32_bf16 v[136:139], v[116:119], v[200:203], v[136:139]
    v_mfma_f32_16x16x32_bf16 v[140:143], v[120:123], v[200:203], v[140:143]
    ds_write_b128 v20, v[224:227] offset:0
    ds_write_b128 v20, v[228:231] offset:7168
    ds_write_b128 v20, v[240:243] offset:28672
    s_cmp_gt_u32 s79, 2
    s_cselect_b32 s4, s6, s86
    s_add_u32 s4, s4, 71680
    v_add_u32 v21, s4, v252
    v_add_u32 v20, 35840, v20
    s_cmp_eq_u32 s79, 2
    s_cbranch_scc1 L_own12
    ds_write_b128 v21, v[232:235] offset:14336
    ds_write_b128 v21, v[236:239] offset:21504
    s_branch L_nown12
L_own12:
    v_mov_b32 v144, v232
    v_mov_b32 v145, v233
    v_mov_b32 v146, v234
    v_mov_b32 v147, v235
    v_mov_b32 v148, v236
    v_mov_b32 v149, v237
    v_mov_b32 v150, v238
    v_mov_b32 v151, v239
L_nown12:
    ds_write_b128 v20, v[124:127] offset:0
    ds_write_b128 v20, v[128:131] offset:7168
    ds_write_b128 v20, v[140:143] offset:28672
    s_cmp_gt_u32 s79, 3
    s_cselect_b32 s4, s6, s86
    s_add_u32 s4, s4, 107520
    v_add_u32 v21, s4, v252
    v_add_u32 v20, 35840, v20
    s_cmp_eq_u32 s79, 3
    s_cbranch_scc1 L_own13
    ds_write_b128 v21, v[132:135] offset:14336
    ds_write_b128 v21, v[136:139] offset:21504
    s_branch L_nown13
L_own13:
    v_mov_b32 v144, v132
    v_mov_b32 v145, v133
    v_mov_b32 v146, v134
    v_mov_b32 v147, v135
    v_mov_b32 v148, v136
    v_mov_b32 v149, v137
    v_mov_b32 v150, v138
    v_mov_b32 v151, v139
L_nown13:
    s_mul_i32 s4, s79, 35840
    v_add_u32 v20, s4, v252
    v_sub_f32 v248, 1.0, v248
    v_lshlrev_b32 v24, 16, v244
    v_and_b32 v25, 0xffff0000, v244
    v_lshlrev_b32 v26, 16, v245
    v_and_b32 v27, 0xffff0000, v245
    v_fmac_f32 v144, v24, v248
    v_fmac_f32 v145, v25, v248
    v_fmac_f32 v146, v26, v248
    v_fmac_f32 v147, v27, v248
    v_lshlrev_b32 v24, 16, v246
    v_and_b32 v25, 0xffff0000, v246
    v_lshlrev_b32 v26, 16, v247
    v_and_b32 v27, 0xffff0000, v247
    v_fmac_f32 v148, v24, v248
    v_fmac_f32 v149, v25, v248
    v_fmac_f32 v150, v26, v248
    v_fmac_f32 v151, v27, v248
    s_waitcnt lgkmcnt(0)
    s_barrier
    ds_read_b128 v[24:27], v20 offset:14336
    ds_read_b128 v[28:31], v20 offset:15360
    ds_read_b128 v[32:35], v20 offset:16384
    ds_read_b128 v[36:39], v20 offset:17408
    ds_read_b128 v[40:43], v20 offset:18432
    ds_read_b128 v[44:47], v20 offset:19456
    ds_read_b128 v[48:51], v20 offset:20480
    ds_read_b128 v[52:55], v20 offset:21504
    ds_read_b128 v[56:59], v20 offset:22528
    ds_read_b128 v[60:63], v20 offset:23552
    ds_read_b128 v[64:67], v20 offset:24576
    ds_read_b128 v[68:71], v20 offset:25600
    ds_read_b128 v[72:75], v20 offset:26624
    ds_read_b128 v[76:79], v20 offset:27648
    s_waitcnt lgkmcnt(7)
    v_pk_add_f32 v[144:145], v[144:145], v[24:25]
    v_pk_add_f32 v[146:147], v[146:147], v[26:27]
    v_pk_add_f32 v[28:29], v[28:29], v[32:33]
    v_pk_add_f32 v[30:31], v[30:31], v[34:35]
    v_pk_add_f32 v[36:37], v[36:37], v[40:41]
    v_pk_add_f32 v[38:39], v[38:39], v[42:43]
    v_pk_add_f32 v[44:45], v[44:45], v[48:49]
    v_pk_add_f32 v[46:47], v[46:47], v[50:51]
    v_pk_add_f32 v[144:145], v[144:145], v[28:29]
    v_pk_add_f32 v[146:147], v[146:147], v[30:31]
    v_pk_add_f32 v[36:37], v[36:37], v[44:45]
    v_pk_add_f32 v[38:39], v[38:39], v[46:47]
    v_pk_add_f32 v[144:145], v[144:145], v[36:37]
    v_pk_add_f32 v[146:147], v[146:147], v[38:39]
    v_cvt_pk_bf16_f32 v144, v144, v145
    v_cvt_pk_bf16_f32 v145, v146, v147
    s_waitcnt lgkmcnt(0)
    v_pk_add_f32 v[148:149], v[148:149], v[52:53]
    v_pk_add_f32 v[150:151], v[150:151], v[54:55]
    v_pk_add_f32 v[56:57], v[56:57], v[60:61]
    v_pk_add_f32 v[58:59], v[58:59], v[62:63]
    v_pk_add_f32 v[64:65], v[64:65], v[68:69]
    v_pk_add_f32 v[66:67], v[66:67], v[70:71]
    v_pk_add_f32 v[72:73], v[72:73], v[76:77]
    v_pk_add_f32 v[74:75], v[74:75], v[78:79]
    v_pk_add_f32 v[148:149], v[148:149], v[56:57]
    v_pk_add_f32 v[150:151], v[150:151], v[58:59]
    v_pk_add_f32 v[64:65], v[64:65], v[72:73]
    v_pk_add_f32 v[66:67], v[66:67], v[74:75]
    v_pk_add_f32 v[148:149], v[148:149], v[64:65]
    v_pk_add_f32 v[150:151], v[150:151], v[66:67]
    v_cvt_pk_bf16_f32 v146, v148, v149
    v_cvt_pk_bf16_f32 v147, v150, v151
    buffer_store_dwordx4 v[144:147], v249, s[60:63], s16 offen offset:64
L_fin:
L_end:
    s_endpgm
.section .rodata,"a"
.p2align 6
.amdhsa_kernel gated_mix__linear_attn_block__mixer_channel_mlp__prompt_kernel
  .amdhsa_next_free_vgpr 256
  .amdhsa_next_free_sgpr 102
  .amdhsa_accum_offset 256
  .amdhsa_group_segment_fixed_size 0
  .amdhsa_kernarg_size 96
  .amdhsa_user_sgpr_count 2
  .amdhsa_user_sgpr_kernarg_segment_ptr 1
  .amdhsa_system_sgpr_workgroup_id_x 1
.end_amdhsa_kernel
```
